```python
import torch

def _softmax(x, axis=-1):
    return torch.softmax(x, dim=axis)
def _gelu(x):
    return torch.nn.functional.gelu(x, approximate="tanh")
def _silu(x):
    return torch.nn.functional.silu(x)
def _sigmoid(x):
    return torch.sigmoid(x)
def _layernorm(x, axis=-1, eps=1e-5):
    m = x.mean(dim=axis, keepdim=True)
    v = x.var(dim=axis, keepdim=True, unbiased=False)
    return (x - m) / torch.sqrt(v + eps)
def _scatter_add(tgt, idx, src, axis=0):
    return tgt.clone().index_add_(axis, idx, src)
def _segment_sum(src, seg, n):
    out = torch.zeros((n,) + src.shape[1:], dtype=src.dtype)
    return out.index_add_(0, seg, src)
def _pad(x, pw):
    flat = tuple(v for pair in reversed(pw) for v in pair)
    return torch.nn.functional.pad(x, flat)

kernel_name = 'concat_heads__softmax_full_mha__linear_attn_block__prompt'

def setup_inputs():

    _w = (lambda a: (lambda t: t.to(torch.bfloat16) if t.is_floating_point() else t)(torch.as_tensor(a)))
    def _A_setup():
        B, S, D = 1, 2048, 512
        return {
            "x": _w((lambda *s: torch.randn(*s, dtype=torch.bfloat16) * 0.2)(B, S, D)),
            "wqkv": _w((lambda *s: torch.randn(*s, dtype=torch.bfloat16) * 0.2)(D, 3 * D)),
            "wo": _w((lambda *s: torch.randn(*s, dtype=torch.bfloat16) * 0.05)(D, D)),
        }
    _A_in = _A_setup()

    def _B_setup():
        B, S, D = 1, 2048, 512
        return {
            "x": _w((lambda *s: torch.randn(*s, dtype=torch.bfloat16) * 0.05)(B, S, D)),
            "wqkv": _w((lambda *s: torch.randn(*s, dtype=torch.bfloat16) * 1.6)(D, 3 * D)),
            "wo": _w((lambda *s: torch.randn(*s, dtype=torch.bfloat16) * 0.05)(D, D)),
        }
    _B_in = _B_setup()

    return {
        "A_x": _A_in["x"],
        "A_wqkv": _A_in["wqkv"],
        "A_wo": _A_in["wo"],
        "B_x": _B_in["x"],
        "B_wqkv": _B_in["wqkv"],
        "B_wo": _B_in["wo"],
    }

def reference(A_x, A_wqkv, A_wo, B_x, B_wqkv, B_wo):
    def _A_ref(x, wqkv, wo):
        B, S, D = x.shape
        H = 32; Dh = D // H
        qkv = (lambda x, *d: x.permute(*d))((x @ wqkv).reshape(B, S, 3, H, Dh), 2, 0, 3, 1, 4)
        q, k, v = qkv[0], qkv[1], qkv[2]
        scale = Dh ** -0.5
        scores = torch.einsum("bhqd,bhkd->bhqk", q, k) * scale
        p = _softmax(scores, axis=-1)
        o = torch.einsum("bhqk,bhkd->bhqd", p, v)
        return (lambda x, *d: x.permute(*d))(o, 0, 2, 1, 3).reshape(B, S, D) @ wo

    def _B_ref(x, wqkv, wo):
        B, S, D = x.shape
        H = 32; Dh = D // H
        qkv = (lambda x, *d: x.permute(*d))((x @ wqkv).reshape(B, S, 3, H, Dh), 2, 0, 3, 1, 4)
        q, k, v = qkv[0], qkv[1], qkv[2]
        phi = lambda t: torch.where(t > 0, t + 1, torch.exp(t)) + 1e-6
        pq, pk = phi(q), phi(k)
        kv = torch.einsum("bhsd,bhse->bhde", pk, v)
        z = torch.einsum("bhsd->bhd", pk)
        num = torch.einsum("bhqd,bhde->bhqe", pq, kv)
        den = torch.einsum("bhqd,bhd->bhq", pq, z)[..., None] + 1e-6
        o = num / den
        return (lambda x, *d: x.permute(*d))(o, 0, 2, 1, 3).reshape(B, S, D) @ wo

    a = _A_ref(A_x, A_wqkv, A_wo)
    b = _B_ref(B_x, B_wqkv, B_wo)
    return torch.concatenate([a, b], axis=-1)
```

```asm
; @launch grid=(256,1,1) block=(512,1,1) lds=163840
.amdgcn_target "amdgcn-amd-amdhsa--gfx950"
.text
.globl concat_heads__softmax_full_mha__linear_attn_block__prompt_kernel
.p2align 8
.type concat_heads__softmax_full_mha__linear_attn_block__prompt_kernel,@function
concat_heads__softmax_full_mha__linear_attn_block__prompt_kernel:
    s_mov_b32 s99, 0x207
    s_cmp_ge_u32 s2, 256
    s_cbranch_scc1 L_end
    s_load_dwordx16 s[64:79], s[0:1], 0
    s_load_dwordx2 s[96:97], s[0:1], 64
    v_and_b32 v1, 63, v0
    v_lshrrev_b32 v2, 6, v0
    s_and_b32 s37, s2, 7
    v_readfirstlane_b32 s3, v2
    s_lshr_b32 s48, s2, 3
    s_and_b32 s38, s48, 7
    s_lshr_b32 s39, s48, 3
    s_and_b32 s48, s37, 3
    s_lshl_b32 s48, s48, 3
    s_add_u32 s40, s48, s38
    s_lshr_b32 s48, s37, 2
    s_lshl_b32 s48, s48, 2
    s_add_u32 s41, s48, s39
    s_and_b32 s48, s37, 1
    s_lshl_b32 s48, s48, 3
    s_add_u32 s42, s48, s38
    s_lshr_b32 s48, s37, 1
    s_lshl_b32 s48, s48, 2
    s_add_u32 s43, s48, s39
    s_lshl_b32 s48, s37, 2
    s_add_u32 s44, s48, s39
    s_mov_b32 s45, s38
    s_lshl_b32 s48, s37, 3
    s_add_u32 s46, s48, s38
    s_mov_b32 s47, s39
    s_cmp_lt_u32 s3, 4
    s_cbranch_scc1 L_awave
    s_sub_u32 s3, s3, 4
    v_lshrrev_b32 v8, 3, v1
    v_and_b32 v9, 7, v1
    v_lshrrev_b32 v10, 4, v1
    v_xor_b32 v11, v9, v10
    v_lshlrev_b32 v11, 4, v11
    v_lshl_add_u32 v120, v8, 10, v11
    s_lshl_b32 s60, s40, 16
    s_lshl_b32 s48, s3, 14
    s_add_u32 s60, s60, s48
    v_xor_b32 v121, 64, v120
    v_add_u32 v121, 8192, v121
    v_and_b32 v10, 1, v10
    v_lshlrev_b32 v10, 2, v10
    v_xor_b32 v11, v9, v10
    v_lshlrev_b32 v11, 4, v11
    v_mul_u32_u24 v8, 3072, v8
    v_add_u32 v122, v8, v11
    v_add_u32 v123, 24576, v122
    s_mul_i32 s61, s3, 49152
    s_lshl_b32 s48, s41, 7
    s_add_u32 s61, s61, s48
    s_lshl_b32 s58, s3, 11
    s_mul_i32 s57, s3, 6144
    s_add_u32 s57, s57, 8192
    s_xor_b32 s62, s38, s39
    s_and_b32 s62, s62, 1
    s_lshl_b32 s62, s62, 2
    s_lshr_b32 s48, s37, 2
    s_lshl_b32 s48, s48, 1
    s_add_u32 s48, s48, s37
    s_and_b32 s48, s48, 3
    s_add_u32 s62, s62, s48
    s_mov_b32 s63, 0
    s_mov_b32 s55, 98304
    s_waitcnt lgkmcnt(0)
    s_mov_b32 s4, s64
    s_mov_b32 s5, s65
    s_mov_b32 s6, 2097152
    s_mov_b32 s7, 0x20000
    s_mov_b32 s8, s66
    s_mov_b32 s9, s67
    s_mov_b32 s10, 1572864
    s_mov_b32 s11, 0x20000
    s_add_u32 s48, s63, s62
    s_and_b32 s48, s48, 7
    s_lshl_b32 s49, s48, 7
    s_add_u32 s49, s49, s60
    s_add_u32 m0, s55, s58
    s_mul_i32 s50, s48, 196608
    buffer_load_dwordx4 v120, s[4:7], s49 offen lds
    s_add_u32 m0, m0, 1024
    s_add_u32 s50, s50, s61
    buffer_load_dwordx4 v121, s[4:7], s49 offen lds
    s_add_u32 m0, s55, s57
    s_add_u32 s63, s63, 1
    buffer_load_dwordx4 v122, s[8:11], s50 offen offset:0 lds
    buffer_load_dwordx4 v122, s[8:11], s50 offen offset:1024 lds
    buffer_load_dwordx4 v122, s[8:11], s50 offen offset:2048 lds
    s_add_u32 m0, m0, 3072
    s_sub_u32 s55, s55, 32768
    buffer_load_dwordx4 v123, s[8:11], s50 offen offset:0 lds
    buffer_load_dwordx4 v123, s[8:11], s50 offen offset:1024 lds
    buffer_load_dwordx4 v123, s[8:11], s50 offen offset:2048 lds
    s_and_b32 s55, s55, 0x1ffff
    s_mov_b32 s12, s68
    s_mov_b32 s13, s69
    s_mov_b32 s14, 524288
    s_mov_b32 s15, 0x20000
    s_mov_b32 s16, s70
    s_mov_b32 s17, s71
    s_mov_b32 s18, 2097152
    s_mov_b32 s19, 0x20000
    s_mov_b32 s20, s72
    s_mov_b32 s21, s73
    s_mov_b32 s22, 1572864
    s_mov_b32 s23, 0x20000
    s_mov_b32 s24, s74
    s_mov_b32 s25, s75
    s_mov_b32 s26, 524288
    s_mov_b32 s27, 0x20000
    s_mov_b32 s28, s76
    s_mov_b32 s29, s77
    s_mov_b32 s30, 4194304
    s_mov_b32 s31, 0x20000
    s_mov_b32 s32, s96
    s_mov_b32 s33, s97
    s_mov_b32 s34, 12582912
    s_mov_b32 s35, 0x20000
    v_mov_b32 v7, 0
    buffer_load_dword v7, v7, s[32:35], 0 offen sc1
LH_ld:
    s_add_u32 s48, s63, s62
    s_and_b32 s48, s48, 7
    s_lshl_b32 s49, s48, 7
    s_add_u32 s49, s49, s60
    s_add_u32 m0, s55, s58
    s_mul_i32 s50, s48, 196608
    buffer_load_dwordx4 v120, s[4:7], s49 offen lds
    s_add_u32 m0, m0, 1024
    s_add_u32 s50, s50, s61
    buffer_load_dwordx4 v121, s[4:7], s49 offen lds
    s_add_u32 m0, s55, s57
    s_add_u32 s63, s63, 1
    buffer_load_dwordx4 v122, s[8:11], s50 offen offset:0 lds
    buffer_load_dwordx4 v122, s[8:11], s50 offen offset:1024 lds
    buffer_load_dwordx4 v122, s[8:11], s50 offen offset:2048 lds
    s_add_u32 m0, m0, 3072
    s_sub_u32 s55, s55, 32768
    buffer_load_dwordx4 v123, s[8:11], s50 offen offset:0 lds
    buffer_load_dwordx4 v123, s[8:11], s50 offen offset:1024 lds
    buffer_load_dwordx4 v123, s[8:11], s50 offen offset:2048 lds
    s_and_b32 s55, s55, 0x1ffff
    s_waitcnt vmcnt(8)
    s_barrier
    s_cmp_lt_u32 s63, 8
    s_cbranch_scc1 LH_ld
    s_waitcnt vmcnt(0)
    s_barrier
    s_branch L_helper
L_awave:
    v_lshlrev_b32 v2, 2, v1
    v_add_u32 v2, 163584, v2
    v_mov_b32 v3, 0
    ds_write_b32 v2, v3
    s_lshl_b32 s48, s3, 8
    s_sub_u32 s48, s48, 2048
    v_add_u32 v2, s48, v2
    ds_write_b32 v2, v3
    ds_write_b32 v2, v3 offset:1024
    s_and_b32 s48, s3, 1
    s_lshl_b32 s58, s48, 12
    s_lshr_b32 s48, s3, 1
    s_lshl_b32 s57, s48, 6
    s_waitcnt lgkmcnt(0)
    s_mov_b32 s4, s64
    s_mov_b32 s5, s65
    s_mov_b32 s6, 2097152
    s_mov_b32 s7, 0x20000
    s_mov_b32 s8, s66
    s_mov_b32 s9, s67
    s_mov_b32 s10, 1572864
    s_mov_b32 s11, 0x20000
    s_mov_b32 s12, s68
    s_mov_b32 s13, s69
    s_mov_b32 s14, 524288
    s_mov_b32 s15, 0x20000
    s_mov_b32 s16, s70
    s_mov_b32 s17, s71
    s_mov_b32 s18, 2097152
    s_mov_b32 s19, 0x20000
    s_mov_b32 s20, s72
    s_mov_b32 s21, s73
    s_mov_b32 s22, 1572864
    s_mov_b32 s23, 0x20000
    s_mov_b32 s24, s74
    s_mov_b32 s25, s75
    s_mov_b32 s26, 524288
    s_mov_b32 s27, 0x20000
    s_mov_b32 s28, s76
    s_mov_b32 s29, s77
    s_mov_b32 s30, 4194304
    s_mov_b32 s31, 0x20000
    s_mov_b32 s32, s96
    s_mov_b32 s33, s97
    s_mov_b32 s34, 12582912
    s_mov_b32 s35, 0x20000
    v_mov_b32 v7, 0
    buffer_load_dword v7, v7, s[32:35], 0 offen sc1
    v_and_b32 v8, 31, v1
    v_lshlrev_b32 v9, 7, v8
    v_add_u32 v9, s58, v9
    v_bfe_u32 v10, v1, 1, 3
    v_lshrrev_b32 v11, 5, v1
    v_xor_b32 v10, v10, v11
    v_xor_b32 v12, 0, v10
    v_lshl_add_u32 v40, v12, 4, v9
    v_xor_b32 v12, 2, v10
    v_lshl_add_u32 v41, v12, 4, v9
    v_xor_b32 v12, 4, v10
    v_lshl_add_u32 v42, v12, 4, v9
    v_xor_b32 v12, 6, v10
    v_lshl_add_u32 v43, v12, 4, v9
    v_bfe_u32 v12, v1, 2, 2
    v_lshl_add_u32 v12, v11, 3, v12
    v_bfe_u32 v13, v1, 4, 1
    v_and_b32 v14, 3, v1
    v_lshlrev_b32 v14, 3, v14
    v_lshl_add_u32 v14, v13, 5, v14
    v_bfe_u32 v12, v1, 2, 2
    v_lshl_add_u32 v14, v12, 7, v14
    v_mul_u32_u24 v12, 3072, v11
    v_add_u32 v14, v14, v12
    v_bfe_u32 v13, v1, 3, 1
    v_lshlrev_b32 v13, 6, v13
    v_xor_b32 v13, s57, v13
    v_add_u32 v44, v13, v14
    v_mov_b32 v48, 0
    v_mov_b32 v49, 0
    v_mov_b32 v50, 0
    v_mov_b32 v51, 0
    v_mov_b32 v52, 0
    v_mov_b32 v53, 0
    v_mov_b32 v54, 0
    v_mov_b32 v55, 0
    v_mov_b32 v56, 0
    v_mov_b32 v57, 0
    v_mov_b32 v58, 0
    v_mov_b32 v59, 0
    v_mov_b32 v60, 0
    v_mov_b32 v61, 0
    v_mov_b32 v62, 0
    v_mov_b32 v63, 0
    v_mov_b32 v64, 0
    v_mov_b32 v65, 0
    v_mov_b32 v66, 0
    v_mov_b32 v67, 0
    v_mov_b32 v68, 0
    v_mov_b32 v69, 0
    v_mov_b32 v70, 0
    v_mov_b32 v71, 0
    v_mov_b32 v72, 0
    v_mov_b32 v73, 0
    v_mov_b32 v74, 0
    v_mov_b32 v75, 0
    v_mov_b32 v76, 0
    v_mov_b32 v77, 0
    v_mov_b32 v78, 0
    v_mov_b32 v79, 0
    v_mov_b32 v80, 0
    v_mov_b32 v81, 0
    v_mov_b32 v82, 0
    v_mov_b32 v83, 0
    v_mov_b32 v84, 0
    v_mov_b32 v85, 0
    v_mov_b32 v86, 0
    v_mov_b32 v87, 0
    v_mov_b32 v88, 0
    v_mov_b32 v89, 0
    v_mov_b32 v90, 0
    v_mov_b32 v91, 0
    v_mov_b32 v92, 0
    v_mov_b32 v93, 0
    v_mov_b32 v94, 0
    v_mov_b32 v95, 0
    s_waitcnt vmcnt(0)
    v_readfirstlane_b32 s36, v7
    s_add_u32 s36, s36, 2654435761
    s_mov_b32 s54, 0
    s_mov_b32 s55, 98304
LA_stage:
    s_barrier
    v_add_u32 v2, s55, v40
    v_add_u32 v3, s55, v41
    v_add_u32 v4, s55, v42
    v_add_u32 v5, s55, v43
    v_add_u32 v6, s55, v44
    ds_read_b128 v[8:11], v2 offset:0
    ds_read_b64_tr_b16 v[12:13], v6 offset:8192
    ds_read_b64_tr_b16 v[14:15], v6 offset:8704
    ds_read_b64_tr_b16 v[16:17], v6 offset:9216
    ds_read_b64_tr_b16 v[18:19], v6 offset:9728
    ds_read_b64_tr_b16 v[20:21], v6 offset:10240
    ds_read_b64_tr_b16 v[22:23], v6 offset:10752
    s_waitcnt lgkmcnt(4)
    v_mfma_f32_32x32x16_bf16 v[48:63], v[12:15], v[8:11], v[48:63]
    ds_read_b128 v[24:27], v3 offset:0
    ds_read_b64_tr_b16 v[28:29], v6 offset:14336
    ds_read_b64_tr_b16 v[30:31], v6 offset:14848
    s_waitcnt lgkmcnt(5)
    v_mfma_f32_32x32x16_bf16 v[64:79], v[16:19], v[8:11], v[64:79]
    ds_read_b64_tr_b16 v[32:33], v6 offset:15360
    ds_read_b64_tr_b16 v[34:35], v6 offset:15872
    s_waitcnt lgkmcnt(5)
    v_mfma_f32_32x32x16_bf16 v[80:95], v[8:11], v[20:23], v[80:95]
    ds_read_b64_tr_b16 v[36:37], v6 offset:16384
    ds_read_b64_tr_b16 v[38:39], v6 offset:16896
    s_waitcnt lgkmcnt(4)
    v_mfma_f32_32x32x16_bf16 v[48:63], v[28:31], v[24:27], v[48:63]
    ds_read_b128 v[8:11], v4 offset:0
    ds_read_b64_tr_b16 v[12:13], v6 offset:20480
    ds_read_b64_tr_b16 v[14:15], v6 offset:20992
    s_waitcnt lgkmcnt(5)
    v_mfma_f32_32x32x16_bf16 v[64:79], v[32:35], v[24:27], v[64:79]
    ds_read_b64_tr_b16 v[16:17], v6 offset:21504
    ds_read_b64_tr_b16 v[18:19], v6 offset:22016
    s_waitcnt lgkmcnt(5)
    v_mfma_f32_32x32x16_bf16 v[80:95], v[24:27], v[36:39], v[80:95]
    ds_read_b64_tr_b16 v[20:21], v6 offset:22528
    ds_read_b64_tr_b16 v[22:23], v6 offset:23040
    s_waitcnt lgkmcnt(4)
    v_mfma_f32_32x32x16_bf16 v[48:63], v[12:15], v[8:11], v[48:63]
    ds_read_b128 v[24:27], v5 offset:0
    ds_read_b64_tr_b16 v[28:29], v6 offset:26624
    ds_read_b64_tr_b16 v[30:31], v6 offset:27136
    s_waitcnt lgkmcnt(5)
    v_mfma_f32_32x32x16_bf16 v[64:79], v[16:19], v[8:11], v[64:79]
    ds_read_b64_tr_b16 v[32:33], v6 offset:27648
    ds_read_b64_tr_b16 v[34:35], v6 offset:28160
    s_waitcnt lgkmcnt(5)
    v_mfma_f32_32x32x16_bf16 v[80:95], v[8:11], v[20:23], v[80:95]
    ds_read_b64_tr_b16 v[36:37], v6 offset:28672
    ds_read_b64_tr_b16 v[38:39], v6 offset:29184
    s_waitcnt lgkmcnt(4)
    v_mfma_f32_32x32x16_bf16 v[48:63], v[28:31], v[24:27], v[48:63]
    s_waitcnt lgkmcnt(2)
    v_mfma_f32_32x32x16_bf16 v[64:79], v[32:35], v[24:27], v[64:79]
    s_waitcnt lgkmcnt(0)
    v_mfma_f32_32x32x16_bf16 v[80:95], v[24:27], v[36:39], v[80:95]
    s_sub_u32 s55, s55, 32768
    s_and_b32 s55, s55, 0x1ffff
    s_add_u32 s54, s54, 1
    s_cmp_lt_u32 s54, 7
    s_cbranch_scc1 LA_stage
    s_setprio 3
    s_lshl_b32 s48, s41, 2
    s_lshr_b32 s49, s3, 1
    s_lshl_b32 s49, s49, 1
    s_add_u32 s48, s48, s49
    s_lshl_b32 s48, s48, 16
    s_lshl_b32 s49, s40, 1
    s_and_b32 s50, s3, 1
    s_add_u32 s49, s49, s50
    s_lshl_b32 s49, s49, 10
    s_add_u32 s48, s48, s49
    s_add_u32 s49, s48, 3145728
    s_add_u32 s50, s48, 3211264
    s_add_u32 s51, s48, 5242880
    s_add_u32 s52, s48, 1048576
    s_add_u32 s53, s48, 1114112
    v_lshlrev_b32 v2, 4, v1
    v_bfe_u32 v3, v1, 4, 1
    v_lshlrev_b32 v3, 16, v3
    v_lshrrev_b32 v4, 5, v1
    v_lshl_add_u32 v3, v4, 9, v3
    v_and_b32 v4, 15, v1
    v_lshl_add_u32 v3, v4, 4, v3
    s_mov_b32 s57, 0x3eb8aa3b
    s_barrier
    ds_read_b128 v[96:99], v40
    ds_read_b64_tr_b16 v[8:9], v44 offset:9216
    ds_read_b64_tr_b16 v[10:11], v44 offset:9728
    ds_read_b128 v[100:103], v41
    ds_read_b64_tr_b16 v[12:13], v44 offset:15360
    ds_read_b64_tr_b16 v[14:15], v44 offset:15872
    ds_read_b128 v[104:107], v42
    ds_read_b64_tr_b16 v[16:17], v44 offset:21504
    ds_read_b64_tr_b16 v[18:19], v44 offset:22016
    ds_read_b128 v[108:111], v43
    ds_read_b64_tr_b16 v[20:21], v44 offset:27648
    ds_read_b64_tr_b16 v[22:23], v44 offset:28160
    s_waitcnt lgkmcnt(9)
    v_mfma_f32_32x32x16_bf16 v[64:79], v[8:11], v[96:99], v[64:79]
    ds_read_b64_tr_b16 v[24:25], v44 offset:10240
    ds_read_b64_tr_b16 v[26:27], v44 offset:10752
    s_waitcnt lgkmcnt(8)
    v_mfma_f32_32x32x16_bf16 v[64:79], v[12:15], v[100:103], v[64:79]
    ds_read_b64_tr_b16 v[28:29], v44 offset:16384
    ds_read_b64_tr_b16 v[30:31], v44 offset:16896
    s_waitcnt lgkmcnt(7)
    v_mfma_f32_32x32x16_bf16 v[64:79], v[16:19], v[104:107], v[64:79]
    ds_read_b64_tr_b16 v[32:33], v44 offset:22528
    ds_read_b64_tr_b16 v[34:35], v44 offset:23040
    s_waitcnt lgkmcnt(6)
    v_mfma_f32_32x32x16_bf16 v[64:79], v[20:23], v[108:111], v[64:79]
    ds_read_b64_tr_b16 v[36:37], v44 offset:28672
    ds_read_b64_tr_b16 v[38:39], v44 offset:29184
    s_waitcnt lgkmcnt(6)
    v_mfma_f32_32x32x16_bf16 v[80:95], v[96:99], v[24:27], v[80:95]
    ds_read_b64_tr_b16 v[8:9], v44 offset:8192
    ds_read_b64_tr_b16 v[10:11], v44 offset:8704
    s_waitcnt lgkmcnt(6)
    v_mfma_f32_32x32x16_bf16 v[80:95], v[100:103], v[28:31], v[80:95]
    ds_read_b64_tr_b16 v[12:13], v44 offset:14336
    ds_read_b64_tr_b16 v[14:15], v44 offset:14848
    s_waitcnt lgkmcnt(6)
    v_mfma_f32_32x32x16_bf16 v[80:95], v[104:107], v[32:35], v[80:95]
    ds_read_b64_tr_b16 v[16:17], v44 offset:20480
    ds_read_b64_tr_b16 v[18:19], v44 offset:20992
    s_waitcnt lgkmcnt(6)
    v_mfma_f32_32x32x16_bf16 v[80:95], v[108:111], v[36:39], v[80:95]
    ds_read_b64_tr_b16 v[20:21], v44 offset:26624
    ds_read_b64_tr_b16 v[22:23], v44 offset:27136
    s_waitcnt lgkmcnt(6)
    v_mfma_f32_32x32x16_bf16 v[48:63], v[8:11], v[96:99], v[48:63]
    v_cvt_pk_bf16_f32 v112, v64, v65
    v_cvt_pk_bf16_f32 v113, v66, v67
    v_cvt_pk_bf16_f32 v114, v68, v69
    v_cvt_pk_bf16_f32 v115, v70, v71
    s_waitcnt lgkmcnt(4)
    v_mfma_f32_32x32x16_bf16 v[48:63], v[12:15], v[100:103], v[48:63]
    v_cvt_pk_bf16_f32 v116, v72, v73
    v_cvt_pk_bf16_f32 v117, v74, v75
    v_cvt_pk_bf16_f32 v118, v76, v77
    v_cvt_pk_bf16_f32 v119, v78, v79
    s_waitcnt lgkmcnt(2)
    v_mfma_f32_32x32x16_bf16 v[48:63], v[16:19], v[104:107], v[48:63]
    buffer_store_dwordx4 v[112:115], v2, s[32:35], s49 offen sc1
    buffer_store_dwordx4 v[116:119], v2, s[32:35], s50 offen sc1
    s_waitcnt lgkmcnt(0)
    v_mfma_f32_32x32x16_bf16 v[48:63], v[20:23], v[108:111], v[48:63]
    v_cvt_pk_bf16_f32 v24, v80, v81
    v_cvt_pk_bf16_f32 v25, v82, v83
    v_cvt_pk_bf16_f32 v26, v84, v85
    v_cvt_pk_bf16_f32 v27, v86, v87
    v_cvt_pk_bf16_f32 v28, v88, v89
    v_cvt_pk_bf16_f32 v29, v90, v91
    v_cvt_pk_bf16_f32 v30, v92, v93
    v_cvt_pk_bf16_f32 v31, v94, v95
    s_nop 1
    v_permlane32_swap_b32 v24, v26
    v_permlane32_swap_b32 v25, v27
    v_permlane32_swap_b32 v28, v30
    v_permlane32_swap_b32 v29, v31
    buffer_store_dwordx4 v[24:27], v3, s[32:35], s51 offen sc1
    buffer_store_dwordx4 v[28:31], v3, s[32:35], s51 offen offset:256 sc1
    v_mul_f32 v48, s57, v48
    v_mul_f32 v49, s57, v49
    v_mul_f32 v50, s57, v50
    v_mul_f32 v51, s57, v51
    v_mul_f32 v52, s57, v52
    v_mul_f32 v53, s57, v53
    v_mul_f32 v54, s57, v54
    v_mul_f32 v55, s57, v55
    v_mul_f32 v56, s57, v56
    v_mul_f32 v57, s57, v57
    v_mul_f32 v58, s57, v58
    v_mul_f32 v59, s57, v59
    v_mul_f32 v60, s57, v60
    v_mul_f32 v61, s57, v61
    v_mul_f32 v62, s57, v62
    v_mul_f32 v63, s57, v63
    v_cvt_pk_bf16_f32 v32, v48, v49
    v_cvt_pk_bf16_f32 v33, v50, v51
    v_cvt_pk_bf16_f32 v34, v52, v53
    v_cvt_pk_bf16_f32 v35, v54, v55
    v_cvt_pk_bf16_f32 v36, v56, v57
    v_cvt_pk_bf16_f32 v37, v58, v59
    v_cvt_pk_bf16_f32 v38, v60, v61
    v_cvt_pk_bf16_f32 v39, v62, v63
    buffer_store_dwordx4 v[32:35], v2, s[32:35], s52 offen sc1
    buffer_store_dwordx4 v[36:39], v2, s[32:35], s53 offen sc1
    v_mov_b32 v4, 163584
    v_mov_b32 v5, 1
    s_lshl_b32 s59, s41, 5
    s_add_u32 s59, s59, s40
    s_lshl_b32 s59, s59, 7
    s_lshl_b32 s50, s3, 15
    s_add_u32 s59, s59, s50
    s_add_u32 s59, s59, 12058624
    s_waitcnt vmcnt(0)
    s_mov_b64 exec, 1
    v_mov_b32 v48, 0
    v_mov_b32 v49, s36
    buffer_store_dword v49, v48, s[32:35], s59 offen sc1
    s_mov_b64 exec, -1
    v_mov_b32 v80, 0
    v_mov_b32 v81, 0
    v_mov_b32 v82, 0
    v_mov_b32 v83, 0
    v_mov_b32 v84, 0
    v_mov_b32 v85, 0
    v_mov_b32 v86, 0
    v_mov_b32 v87, 0
    v_mov_b32 v88, 0
    v_mov_b32 v89, 0
    v_mov_b32 v90, 0
    v_mov_b32 v91, 0
    v_mov_b32 v92, 0
    v_mov_b32 v93, 0
    v_mov_b32 v94, 0
    v_mov_b32 v95, 0
    v_mov_b32 v96, 0
    v_mov_b32 v97, 0
    v_mov_b32 v98, 0
    v_mov_b32 v99, 0
    v_mov_b32 v100, 0
    v_mov_b32 v101, 0
    v_mov_b32 v102, 0
    v_mov_b32 v103, 0
    v_mov_b32 v104, 0
    v_mov_b32 v105, 0
    v_mov_b32 v106, 0
    v_mov_b32 v107, 0
    v_mov_b32 v108, 0
    v_mov_b32 v109, 0
    v_mov_b32 v110, 0
    v_mov_b32 v111, 0
    v_mov_b32 v72, 0
    v_mov_b32 v73, 0
    v_mov_b32 v74, 0
    v_mov_b32 v75, 0
    v_mov_b32 v76, 0
    v_mov_b32 v77, 0
    v_mov_b32 v78, 0
    v_mov_b32 v79, 0
    v_mov_b32 v43, v2
    v_add_u32 v6, 32768, v2
    v_add_u32 v7, 49152, v2
    v_and_b32 v3, 3, v1
    v_lshlrev_b32 v3, 8, v3
    v_add_u32 v3, 161536, v3
    s_lshl_b32 s48, s3, 8
    s_add_u32 s48, s48, 161536
    v_lshlrev_b32 v40, 2, v1
    v_add_u32 v40, s48, v40
    v_mov_b32 v41, 1
    v_lshrrev_b32 v8, 4, v1
    v_lshlrev_b32 v47, 2, v8
    v_and_b32 v46, 15, v1
    v_xor_b32 v47, v47, v46
    v_lshlrev_b32 v47, 4, v47
    v_lshl_add_u32 v47, v8, 10, v47
    v_bfe_u32 v8, v1, 2, 2
    v_xor_b32 v46, s3, v8
    v_lshlrev_b32 v46, 6, v46
    v_lshl_add_u32 v46, v8, 8, v46
    v_lshrrev_b32 v8, 5, v1
    v_lshl_add_u32 v46, v8, 10, v46
    v_bfe_u32 v8, v1, 4, 1
    v_lshl_add_u32 v46, v8, 5, v46
    v_and_b32 v8, 3, v1
    v_lshl_add_u32 v46, v8, 3, v46
    v_add_u32 v46, 65536, v46
    s_mov_b32 s60, 0xffff
    s_mov_b32 s61, 0xffff
    s_lshl_b32 s48, s44, 16
    s_lshl_b32 s62, s3, 11
    s_add_u32 s48, s48, s62
    s_lshl_b32 s49, s45, 13
    s_add_u32 s48, s48, s49
    s_add_u32 s63, s48, 3145728
    s_add_u32 s57, s48, 5242880
    s_add_u32 s58, s48, 1048576
    s_lshl_b32 s49, s45, 2
    s_add_u32 s49, s49, s3
    s_lshl_b32 s49, s49, 16
    s_lshl_b32 s50, s44, 10
    s_add_u32 s49, s49, s50
    s_add_u32 s40, s49, 9437184
    s_add_u32 s41, s40, 32768
    s_lshl_b32 s49, s45, 5
    s_add_u32 s49, s49, s44
    s_lshl_b32 s49, s49, 7
    s_lshl_b32 s50, s3, 15
    s_add_u32 s49, s49, s50
    s_add_u32 s98, s49, 12451840
    v_mov_b32 v116, 0
    v_mov_b32 v117, s36
    s_lshr_b32 s52, s44, 2
    s_lshl_b32 s52, s52, 5
    s_add_u32 s52, s52, s3
    s_lshl_b32 s52, s52, 7
    s_and_b32 s49, s44, 2
    s_lshl_b32 s49, s49, 15
    s_add_u32 s52, s52, s49
    s_add_u32 s52, s52, 12058624
    v_and_b32 v44, 1, v1
    v_lshlrev_b32 v44, 15, v44
    s_lshl_b32 s48, s45, 9
    s_add_u32 s52, s52, s48
    v_mov_b32 v32, 0
    v_mov_b32 v33, 0
    v_mov_b32 v34, 0
    v_mov_b32 v35, 0
    v_mov_b32 v36, 0
    v_mov_b32 v37, 0
    v_mov_b32 v38, 0
    v_mov_b32 v39, 0
    s_mov_b32 exec_lo, 0x110000
    s_mov_b32 exec_hi, 0x110000
    v_mov_b32 v32, 0x3f803f80
    v_mov_b32 v33, 0x3f803f80
    v_mov_b32 v34, 0x3f803f80
    v_mov_b32 v35, 0x3f803f80
    v_mov_b32 v36, 0x3f803f80
    v_mov_b32 v37, 0x3f803f80
    v_mov_b32 v38, 0x3f803f80
    v_mov_b32 v39, 0x3f803f80
    s_mov_b64 exec, -1
    s_add_u32 m0, s62, 32768
    v_mov_b32 v24, v32
    v_mov_b32 v25, v33
    v_mov_b32 v26, v34
    v_mov_b32 v27, v35
    v_mov_b32 v28, v36
    v_mov_b32 v29, v37
    v_mov_b32 v30, v38
    v_mov_b32 v31, v39
    s_mov_b64 exec, 3
    s_mov_b32 s56, 0
Lgp_1:
    buffer_load_dword v45, v44, s[32:35], s52 offen sc1
    s_add_u32 s56, s56, 1
    s_waitcnt vmcnt(0)
    v_cmp_ne_u32 vcc, s36, v45
    s_cbranch_vccz Lgpd_2
    s_cmp_lt_u32 s56, 400000
    s_cbranch_scc1 Lgp_1
Lgpd_2:
    s_mov_b64 exec, -1
    buffer_load_dwordx4 v43, s[32:35], s63 offen offset:0 sc1 lds
    buffer_load_dwordx4 v43, s[32:35], s63 offen offset:1024 sc1 lds
    s_add_u32 m0, m0, 8192
    s_nop 0
    buffer_load_dwordx4 v43, s[32:35], s57 offen offset:0 sc1 lds
    buffer_load_dwordx4 v43, s[32:35], s57 offen offset:1024 sc1 lds
    buffer_load_dwordx4 v[8:11], v43, s[32:35], s58 offen sc1
    buffer_load_dwordx4 v[12:15], v43, s[32:35], s58 offen offset:1024 sc1
    s_mov_b64 exec, 1
    ds_add_u32 v4, v5 offset:24
    s_mov_b64 exec, -1
    v_mov_b32 v5, 0xdddddddd
    s_mov_b32 s57, 1
    s_mov_b32 s55, 49152
    v_add_u32 v44, 1024, v3
    s_mov_b32 s63, 0
    s_waitcnt vmcnt(2)
    ds_write_b32 v40, v41
    v_mov_b32 v41, 2
    s_mov_b32 s56, 0
LA_first:
    ds_read_b32 v42, v3
    ds_read_b128 v[16:19], v6 offset:0
    ds_read_b128 v[20:23], v6 offset:1024
    s_mov_b64 exec, s[60:61]
    ds_read_b128 v[24:27], v6 offset:8192
    ds_read_b128 v[28:31], v6 offset:8448
    s_mov_b64 exec, -1
    s_add_u32 s56, s56, 1
    s_waitcnt lgkmcnt(4)
    v_cmp_gt_u32 vcc, 1, v42
    s_cbranch_vccz LA_go
    s_waitcnt lgkmcnt(0)
    s_cmp_lt_u32 s56, 4000000
    s_cbranch_scc1 LA_first
LA_go:
    s_waitcnt vmcnt(0) lgkmcnt(3)
    v_mfma_f32_32x32x16_bf16 v[48:63], v[16:19], v[8:11], 0
    s_setprio 1
    v_mov_b32 v3, v44
    s_mov_b32 s54, 0
    s_mov_b32 s57, 2
    s_nop 7
.p2align 4
LA_attn:
    v_exp_f32 v48, v48
    v_exp_f32 v49, v49
    v_smfmac_f32_32x32x32_bf16 v[96:111], v[36:39], v[72:79], v5
    s_waitcnt lgkmcnt(0)
    s_mov_b64 exec, s[60:61]
    ds_read_b128 v[32:35], v6 offset:9216
    ds_read_b128 v[36:39], v6 offset:9472
    s_mov_b64 exec, -1
    v_exp_f32 v50, v50
    v_exp_f32 v51, v51
    v_exp_f32 v52, v52
    v_exp_f32 v53, v53
    v_mfma_f32_32x32x16_bf16 v[64:79], v[16:19], v[12:15], 0
    ds_read_b128 v[16:19], v6 offset:2048
    v_exp_f32 v54, v54
    v_exp_f32 v55, v55
    v_exp_f32 v56, v56
    v_exp_f32 v57, v57
    v_smfmac_f32_32x32x32_bf16 v[80:95], v[24:27], v[48:55], v5
    v_exp_f32 v58, v58
    v_exp_f32 v59, v59
    v_exp_f32 v60, v60
    v_exp_f32 v61, v61
    v_exp_f32 v62, v62
    v_exp_f32 v63, v63
    v_exp_f32 v64, v64
    v_exp_f32 v65, v65
    v_smfmac_f32_32x32x32_bf16 v[80:95], v[28:31], v[56:63], v5
    ds_write_b32 v40, v41
    v_exp_f32 v66, v66
    v_exp_f32 v67, v67
    v_exp_f32 v68, v68
    v_exp_f32 v69, v69
    v_mfma_f32_32x32x16_bf16 v[48:63], v[20:23], v[8:11], 0
    v_exp_f32 v70, v70
    v_exp_f32 v71, v71
    v_exp_f32 v72, v72
    v_exp_f32 v73, v73
    v_smfmac_f32_32x32x32_bf16 v[96:111], v[24:27], v[64:71], v5
    v_exp_f32 v74, v74
    v_exp_f32 v75, v75
    v_exp_f32 v76, v76
    v_exp_f32 v77, v77
    v_exp_f32 v78, v78
    v_exp_f32 v79, v79
    v_exp_f32 v48, v48
    v_exp_f32 v49, v49
    v_smfmac_f32_32x32x32_bf16 v[96:111], v[28:31], v[72:79], v5
    s_waitcnt lgkmcnt(0)
    s_mov_b64 exec, s[60:61]
    ds_read_b128 v[24:27], v6 offset:10240
    ds_read_b128 v[28:31], v6 offset:10496
    s_mov_b64 exec, -1
    v_exp_f32 v50, v50
    v_exp_f32 v51, v51
    v_exp_f32 v52, v52
    v_exp_f32 v53, v53
    v_mfma_f32_32x32x16_bf16 v[64:79], v[20:23], v[12:15], 0
    ds_read_b128 v[20:23], v6 offset:3072
    v_exp_f32 v54, v54
    v_exp_f32 v55, v55
    v_exp_f32 v56, v56
    v_exp_f32 v57, v57
    v_smfmac_f32_32x32x32_bf16 v[80:95], v[32:35], v[48:55], v5
    v_exp_f32 v58, v58
    v_exp_f32 v59, v59
    v_exp_f32 v60, v60
    v_exp_f32 v61, v61
    v_exp_f32 v62, v62
    v_exp_f32 v63, v63
    v_exp_f32 v64, v64
    v_exp_f32 v65, v65
    v_smfmac_f32_32x32x32_bf16 v[80:95], v[36:39], v[56:63], v5
    v_exp_f32 v66, v66
    v_exp_f32 v67, v67
    v_exp_f32 v68, v68
    v_exp_f32 v69, v69
    v_mfma_f32_32x32x16_bf16 v[48:63], v[16:19], v[8:11], 0
    v_exp_f32 v70, v70
    v_exp_f32 v71, v71
    v_exp_f32 v72, v72
    v_exp_f32 v73, v73
    v_smfmac_f32_32x32x32_bf16 v[96:111], v[32:35], v[64:71], v5
    v_exp_f32 v74, v74
    v_exp_f32 v75, v75
    v_exp_f32 v76, v76
    v_exp_f32 v77, v77
    v_exp_f32 v78, v78
    v_exp_f32 v79, v79
    v_exp_f32 v48, v48
    v_exp_f32 v49, v49
    v_smfmac_f32_32x32x32_bf16 v[96:111], v[36:39], v[72:79], v5
    s_waitcnt lgkmcnt(0)
    s_mov_b64 exec, s[60:61]
    ds_read_b128 v[32:35], v6 offset:11264
    ds_read_b128 v[36:39], v6 offset:11520
    s_mov_b64 exec, -1
    v_exp_f32 v50, v50
    v_exp_f32 v51, v51
    v_exp_f32 v52, v52
    v_exp_f32 v53, v53
    v_mfma_f32_32x32x16_bf16 v[64:79], v[16:19], v[12:15], 0
    ds_read_b128 v[16:19], v6 offset:4096
    v_exp_f32 v54, v54
    v_exp_f32 v55, v55
    v_exp_f32 v56, v56
    v_exp_f32 v57, v57
    v_smfmac_f32_32x32x32_bf16 v[80:95], v[24:27], v[48:55], v5
    v_exp_f32 v58, v58
    v_exp_f32 v59, v59
    v_exp_f32 v60, v60
    v_exp_f32 v61, v61
    v_exp_f32 v62, v62
    v_exp_f32 v63, v63
    v_exp_f32 v64, v64
    v_exp_f32 v65, v65
    v_smfmac_f32_32x32x32_bf16 v[80:95], v[28:31], v[56:63], v5
    v_exp_f32 v66, v66
    v_exp_f32 v67, v67
    v_exp_f32 v68, v68
    v_exp_f32 v69, v69
    v_mfma_f32_32x32x16_bf16 v[48:63], v[20:23], v[8:11], 0
    v_exp_f32 v70, v70
    v_exp_f32 v71, v71
    v_exp_f32 v72, v72
    v_exp_f32 v73, v73
    v_smfmac_f32_32x32x32_bf16 v[96:111], v[24:27], v[64:71], v5
    s_cmp_eq_u32 s63, 2
    s_cbranch_scc1 LA_pre2
LA_pre2d:
    v_exp_f32 v74, v74
    v_exp_f32 v75, v75
    v_exp_f32 v76, v76
    v_exp_f32 v77, v77
    v_exp_f32 v78, v78
    v_exp_f32 v79, v79
    v_exp_f32 v48, v48
    v_exp_f32 v49, v49
    v_smfmac_f32_32x32x32_bf16 v[96:111], v[28:31], v[72:79], v5
    s_waitcnt lgkmcnt(0)
    s_mov_b64 exec, s[60:61]
    ds_read_b128 v[24:27], v6 offset:12288
    ds_read_b128 v[28:31], v6 offset:12544
    s_mov_b64 exec, -1
    v_exp_f32 v50, v50
    v_exp_f32 v51, v51
    v_exp_f32 v52, v52
    v_exp_f32 v53, v53
    v_mfma_f32_32x32x16_bf16 v[64:79], v[20:23], v[12:15], 0
    ds_read_b128 v[20:23], v6 offset:5120
    v_exp_f32 v54, v54
    v_exp_f32 v55, v55
    v_exp_f32 v56, v56
    v_exp_f32 v57, v57
    v_smfmac_f32_32x32x32_bf16 v[80:95], v[32:35], v[48:55], v5
    v_exp_f32 v58, v58
    v_exp_f32 v59, v59
    v_exp_f32 v60, v60
    v_exp_f32 v61, v61
    v_exp_f32 v62, v62
    v_exp_f32 v63, v63
    v_exp_f32 v64, v64
    v_exp_f32 v65, v65
    v_smfmac_f32_32x32x32_bf16 v[80:95], v[36:39], v[56:63], v5
    v_exp_f32 v66, v66
    v_exp_f32 v67, v67
    v_exp_f32 v68, v68
    v_exp_f32 v69, v69
    v_mfma_f32_32x32x16_bf16 v[48:63], v[16:19], v[8:11], 0
    ds_read_b32 v42, v3
    v_exp_f32 v70, v70
    v_exp_f32 v71, v71
    v_exp_f32 v72, v72
    v_exp_f32 v73, v73
    v_smfmac_f32_32x32x32_bf16 v[96:111], v[32:35], v[64:71], v5
    v_exp_f32 v74, v74
    v_exp_f32 v75, v75
    v_exp_f32 v76, v76
    v_exp_f32 v77, v77
    v_exp_f32 v78, v78
    v_exp_f32 v79, v79
    v_exp_f32 v48, v48
    v_exp_f32 v49, v49
    v_smfmac_f32_32x32x32_bf16 v[96:111], v[36:39], v[72:79], v5
    s_waitcnt lgkmcnt(0)
    s_mov_b64 exec, s[60:61]
    ds_read_b128 v[32:35], v6 offset:13312
    ds_read_b128 v[36:39], v6 offset:13568
    s_mov_b64 exec, -1
    v_exp_f32 v50, v50
    v_exp_f32 v51, v51
    v_exp_f32 v52, v52
    v_exp_f32 v53, v53
    v_mfma_f32_32x32x16_bf16 v[64:79], v[16:19], v[12:15], 0
    ds_read_b128 v[16:19], v6 offset:6144
    v_exp_f32 v54, v54
    v_exp_f32 v55, v55
    v_exp_f32 v56, v56
    v_exp_f32 v57, v57
    v_smfmac_f32_32x32x32_bf16 v[80:95], v[24:27], v[48:55], v5
    v_exp_f32 v58, v58
    v_exp_f32 v59, v59
    v_exp_f32 v60, v60
    v_exp_f32 v61, v61
    v_exp_f32 v62, v62
    v_exp_f32 v63, v63
    v_exp_f32 v64, v64
    v_exp_f32 v65, v65
    v_smfmac_f32_32x32x32_bf16 v[80:95], v[28:31], v[56:63], v5
    v_exp_f32 v66, v66
    v_exp_f32 v67, v67
    v_exp_f32 v68, v68
    v_exp_f32 v69, v69
    v_mfma_f32_32x32x16_bf16 v[48:63], v[20:23], v[8:11], 0
    v_cmp_gt_u32 vcc, s57, v42
    v_exp_f32 v70, v70
    v_exp_f32 v71, v71
    v_exp_f32 v72, v72
    v_exp_f32 v73, v73
    v_smfmac_f32_32x32x32_bf16 v[96:111], v[24:27], v[64:71], v5
    s_cbranch_vccnz LA_stall
LA_resume:
    v_exp_f32 v74, v74
    v_exp_f32 v75, v75
    v_exp_f32 v76, v76
    v_exp_f32 v77, v77
    v_exp_f32 v78, v78
    v_exp_f32 v79, v79
    v_exp_f32 v48, v48
    v_exp_f32 v49, v49
    v_smfmac_f32_32x32x32_bf16 v[96:111], v[28:31], v[72:79], v5
    s_waitcnt lgkmcnt(0)
    s_mov_b64 exec, s[60:61]
    ds_read_b128 v[24:27], v6 offset:14336
    ds_read_b128 v[28:31], v6 offset:14592
    s_mov_b64 exec, -1
    v_exp_f32 v50, v50
    v_exp_f32 v51, v51
    v_exp_f32 v52, v52
    v_exp_f32 v53, v53
    v_mfma_f32_32x32x16_bf16 v[64:79], v[20:23], v[12:15], 0
    ds_read_b128 v[20:23], v6 offset:7168
    v_exp_f32 v54, v54
    v_exp_f32 v55, v55
    v_exp_f32 v56, v56
    v_exp_f32 v57, v57
    v_smfmac_f32_32x32x32_bf16 v[80:95], v[32:35], v[48:55], v5
    s_add_u32 s57, s57, 1
    v_exp_f32 v58, v58
    v_exp_f32 v59, v59
    v_exp_f32 v60, v60
    v_exp_f32 v61, v61
    v_exp_f32 v62, v62
    v_exp_f32 v63, v63
    v_exp_f32 v64, v64
    v_exp_f32 v65, v65
    v_smfmac_f32_32x32x32_bf16 v[80:95], v[36:39], v[56:63], v5
    v_exp_f32 v66, v66
    v_exp_f32 v67, v67
    v_exp_f32 v68, v68
    v_exp_f32 v69, v69
    v_mfma_f32_32x32x16_bf16 v[48:63], v[16:19], v[8:11], 0
    v_exp_f32 v70, v70
    v_exp_f32 v71, v71
    v_exp_f32 v72, v72
    v_exp_f32 v73, v73
    v_smfmac_f32_32x32x32_bf16 v[96:111], v[32:35], v[64:71], v5
    v_exp_f32 v74, v74
    v_exp_f32 v75, v75
    v_exp_f32 v76, v76
    v_exp_f32 v77, v77
    v_exp_f32 v78, v78
    v_exp_f32 v79, v79
    v_exp_f32 v48, v48
    v_exp_f32 v49, v49
    v_smfmac_f32_32x32x32_bf16 v[96:111], v[36:39], v[72:79], v5
    s_waitcnt lgkmcnt(0)
    s_mov_b64 exec, s[60:61]
    ds_read_b128 v[32:35], v6 offset:15360
    ds_read_b128 v[36:39], v6 offset:15616
    s_mov_b64 exec, -1
    v_exp_f32 v50, v50
    v_exp_f32 v51, v51
    v_exp_f32 v52, v52
    v_exp_f32 v53, v53
    v_mfma_f32_32x32x16_bf16 v[64:79], v[16:19], v[12:15], 0
    ds_read_b128 v[16:19], v7 offset:0
    v_exp_f32 v54, v54
    v_exp_f32 v55, v55
    v_exp_f32 v56, v56
    v_exp_f32 v57, v57
    v_smfmac_f32_32x32x32_bf16 v[80:95], v[24:27], v[48:55], v5
    s_cmp_eq_u32 s54, 7
    s_cbranch_scc1 LA_hint
LA_hinted:
    v_exp_f32 v58, v58
    v_exp_f32 v59, v59
    v_exp_f32 v60, v60
    v_exp_f32 v61, v61
    v_exp_f32 v62, v62
    v_exp_f32 v63, v63
    v_exp_f32 v64, v64
    v_exp_f32 v65, v65
    v_smfmac_f32_32x32x32_bf16 v[80:95], v[28:31], v[56:63], v5
    v_exp_f32 v66, v66
    v_exp_f32 v67, v67
    v_exp_f32 v68, v68
    v_exp_f32 v69, v69
    v_mfma_f32_32x32x16_bf16 v[48:63], v[20:23], v[8:11], 0
    s_add_u32 s55, s55, 16384
    s_cmp_eq_u32 s55, 98304
    v_exp_f32 v70, v70
    v_exp_f32 v71, v71
    v_exp_f32 v72, v72
    v_exp_f32 v73, v73
    v_smfmac_f32_32x32x32_bf16 v[96:111], v[24:27], v[64:71], v5
    s_cselect_b32 s55, 0, s55
    v_exp_f32 v74, v74
    v_exp_f32 v75, v75
    v_exp_f32 v76, v76
    v_exp_f32 v77, v77
    v_exp_f32 v78, v78
    v_exp_f32 v79, v79
    v_exp_f32 v48, v48
    v_exp_f32 v49, v49
    v_smfmac_f32_32x32x32_bf16 v[96:111], v[28:31], v[72:79], v5
    s_waitcnt lgkmcnt(0)
    s_mov_b64 exec, s[60:61]
    ds_read_b128 v[24:27], v7 offset:8192
    ds_read_b128 v[28:31], v7 offset:8448
    s_mov_b64 exec, -1
    v_exp_f32 v50, v50
    v_exp_f32 v51, v51
    v_exp_f32 v52, v52
    v_exp_f32 v53, v53
    v_mfma_f32_32x32x16_bf16 v[64:79], v[20:23], v[12:15], 0
    ds_read_b128 v[20:23], v7 offset:1024
    v_exp_f32 v54, v54
    v_exp_f32 v55, v55
    v_exp_f32 v56, v56
    v_exp_f32 v57, v57
    v_smfmac_f32_32x32x32_bf16 v[80:95], v[32:35], v[48:55], v5
    v_exp_f32 v58, v58
    v_exp_f32 v59, v59
    v_exp_f32 v60, v60
    v_exp_f32 v61, v61
    v_exp_f32 v62, v62
    v_exp_f32 v63, v63
    v_exp_f32 v64, v64
    v_exp_f32 v65, v65
    v_smfmac_f32_32x32x32_bf16 v[80:95], v[36:39], v[56:63], v5
    v_exp_f32 v66, v66
    v_exp_f32 v67, v67
    v_exp_f32 v68, v68
    v_exp_f32 v69, v69
    v_mfma_f32_32x32x16_bf16 v[48:63], v[16:19], v[8:11], 0
    v_exp_f32 v70, v70
    v_exp_f32 v71, v71
    v_exp_f32 v72, v72
    v_exp_f32 v73, v73
    v_smfmac_f32_32x32x32_bf16 v[96:111], v[32:35], v[64:71], v5
    s_add_u32 s54, s54, 1
    s_cmp_lt_u32 s54, 7
    v_exp_f32 v74, v74
    v_exp_f32 v75, v75
    v_exp_f32 v76, v76
    v_exp_f32 v77, v77
    v_exp_f32 v78, v78
    v_exp_f32 v79, v79
    v_mov_b32 v6, v7
    v_add_u32 v7, s55, v43
    v_add_u32 v41, 1, v41
    s_cbranch_scc1 LA_attn
    s_cmp_eq_u32 s54, 7
    s_cbranch_scc1 LA_pre
    v_smfmac_f32_32x32x32_bf16 v[96:111], v[36:39], v[72:79], v5
    s_setprio 3
    s_waitcnt lgkmcnt(0)
    s_mov_b32 s59, 0
    s_nop 7
    s_nop 3
LA_fin:
    s_mov_b32 s48, 0x21800000
    s_mov_b32 s49, 0x71800000
    v_rcp_f32 v89, v88
    v_cmp_le_f32 vcc, s48, v88
    v_cmp_ge_f32 s[50:51], s49, v88
    v_pk_mul_f32 v[80:81], v[80:81], v[88:89] op_sel:[0,1] op_sel_hi:[1,1]
    v_pk_mul_f32 v[82:83], v[82:83], v[88:89] op_sel:[0,1] op_sel_hi:[1,1]
    v_pk_mul_f32 v[84:85], v[84:85], v[88:89] op_sel:[0,1] op_sel_hi:[1,1]
    v_pk_mul_f32 v[86:87], v[86:87], v[88:89] op_sel:[0,1] op_sel_hi:[1,1]
    s_and_b64 s[92:93], vcc, s[50:51]
    v_pk_add_f32 v[90:91], v[80:81], v[82:83]
    v_pk_add_f32 v[92:93], v[84:85], v[86:87]
    v_pk_add_f32 v[90:91], v[90:91], v[92:93]
    v_add_f32 v90, v90, v91
    v_cmp_class_f32 vcc, v90, s99
    v_cvt_pk_bf16_f32 v16, v80, v81
    v_cvt_pk_bf16_f32 v17, v82, v83
    v_cvt_pk_bf16_f32 v18, v84, v85
    v_cvt_pk_bf16_f32 v19, v86, v87
    s_andn2_b64 s[92:93], s[92:93], vcc
    v_rcp_f32 v105, v104
    v_cmp_le_f32 vcc, s48, v104
    v_cmp_ge_f32 s[50:51], s49, v104
    v_pk_mul_f32 v[96:97], v[96:97], v[104:105] op_sel:[0,1] op_sel_hi:[1,1]
    v_pk_mul_f32 v[98:99], v[98:99], v[104:105] op_sel:[0,1] op_sel_hi:[1,1]
    v_pk_mul_f32 v[100:101], v[100:101], v[104:105] op_sel:[0,1] op_sel_hi:[1,1]
    v_pk_mul_f32 v[102:103], v[102:103], v[104:105] op_sel:[0,1] op_sel_hi:[1,1]
    s_and_b64 s[94:95], vcc, s[50:51]
    v_pk_add_f32 v[106:107], v[96:97], v[98:99]
    v_pk_add_f32 v[108:109], v[100:101], v[102:103]
    v_pk_add_f32 v[106:107], v[106:107], v[108:109]
    v_add_f32 v106, v106, v107
    v_cmp_class_f32 vcc, v106, s99
    v_cvt_pk_bf16_f32 v20, v96, v97
    v_cvt_pk_bf16_f32 v21, v98, v99
    v_cvt_pk_bf16_f32 v22, v100, v101
    v_cvt_pk_bf16_f32 v23, v102, v103
    s_andn2_b64 s[94:95], s[94:95], vcc
    s_and_b64 s[92:93], s[92:93], s[94:95]
    s_cmp_eq_u64 s[92:93], -1
    s_cbranch_scc1 LA_ok
    s_cmp_eq_u32 s59, 0
    s_cbranch_scc1 LA_fallback
LA_ok:
    v_min_u32 v16, -2, v16
    v_min_u32 v19, -2, v19
    v_min_u32 v20, -2, v20
    v_min_u32 v23, -2, v23
    buffer_store_dwordx4 v[16:19], v43, s[32:35], s40 offen sc1
    buffer_store_dwordx4 v[20:23], v43, s[32:35], s41 offen sc1
    v_mov_b32 v5, 1
    v_add_u32 v40, 4294901760, v46
    s_mov_b64 exec, 1
    ds_add_u32 v4, v5 offset:40
    s_mov_b64 exec, -1
    s_cmp_eq_u32 s63, 1
    s_cbranch_scc1 LA_have
    s_mov_b32 s57, 64
    s_mov_b32 s56, 0
Lpw_3:
    ds_read_b32 v42, v44
    s_add_u32 s56, s56, 1
    s_waitcnt lgkmcnt(0)
    v_cmp_gt_u32 vcc, s57, v42
    s_cbranch_vccz Lpwd_4
    s_cmp_lt_u32 s56, 4000000
    s_cbranch_scc1 Lpw_3
Lpwd_4:
    ds_read_b64_tr_b16 v[128:129], v46 offset:0
    ds_read_b64_tr_b16 v[130:131], v46 offset:2048
    ds_read_b64_tr_b16 v[132:133], v46 offset:4096
    ds_read_b64_tr_b16 v[134:135], v46 offset:6144
    ds_read_b64_tr_b16 v[136:137], v46 offset:8192
    ds_read_b64_tr_b16 v[138:139], v46 offset:10240
    ds_read_b64_tr_b16 v[140:141], v46 offset:12288
    ds_read_b64_tr_b16 v[142:143], v46 offset:14336
    ds_read_b64_tr_b16 v[144:145], v46 offset:16384
    ds_read_b64_tr_b16 v[146:147], v46 offset:18432
    ds_read_b64_tr_b16 v[148:149], v46 offset:20480
    ds_read_b64_tr_b16 v[150:151], v46 offset:22528
    ds_read_b64_tr_b16 v[152:153], v46 offset:24576
    ds_read_b64_tr_b16 v[154:155], v46 offset:26624
    ds_read_b64_tr_b16 v[156:157], v46 offset:28672
    ds_read_b64_tr_b16 v[158:159], v46 offset:30720
    ds_read_b64_tr_b16 v[160:161], v46 offset:32768
    ds_read_b64_tr_b16 v[162:163], v46 offset:34816
    ds_read_b64_tr_b16 v[164:165], v46 offset:36864
    ds_read_b64_tr_b16 v[166:167], v46 offset:38912
    ds_read_b64_tr_b16 v[168:169], v46 offset:40960
    ds_read_b64_tr_b16 v[170:171], v46 offset:43008
    ds_read_b64_tr_b16 v[172:173], v46 offset:45056
    ds_read_b64_tr_b16 v[174:175], v46 offset:47104
    ds_read_b64_tr_b16 v[176:177], v46 offset:49152
    ds_read_b64_tr_b16 v[178:179], v46 offset:51200
    ds_read_b64_tr_b16 v[180:181], v46 offset:53248
    ds_read_b64_tr_b16 v[182:183], v46 offset:55296
    ds_read_b64_tr_b16 v[184:185], v46 offset:57344
    ds_read_b64_tr_b16 v[186:187], v46 offset:59392
    s_waitcnt lgkmcnt(0)
    s_mov_b64 exec, 1
    ds_add_u32 v4, v5 offset:44
    s_mov_b64 exec, -1
LA_have:
    v_lshlrev_b32 v6, 7, v1
    s_lshr_b32 s59, s46, 3
    s_lshl_b32 s59, s59, 12
    s_lshl_b32 s51, s3, 10
    s_add_u32 s59, s59, s51
    s_and_b32 s51, s46, 6
    s_lshl_b32 s51, s51, 14
    s_add_u32 s59, s59, s51
    s_add_u32 s59, s59, 12451840
    s_mov_b32 s56, 0
Llw_5:
    ds_read_b32 v7, v4 offset:40
    s_add_u32 s56, s56, 1
    s_waitcnt lgkmcnt(0)
    v_readfirstlane_b32 s53, v7
    s_cmp_ge_u32 s53, 4
    s_cbranch_scc1 Llwd_6
    s_cmp_lt_u32 s56, 4000000
    s_cbranch_scc1 Llw_5
Llwd_6:
    s_lshl_b32 s55, s3, 13
    s_lshl_b32 s62, s46, 15
    s_add_u32 s62, s62, s55
    s_add_u32 s62, s62, 9437184
    s_mov_b64 exec, 0xff
    buffer_load_dword v7, v6, s[32:35], s59 offen sc1
    s_mov_b64 exec, -1
    v_and_b32 v3, 3, v1
    v_lshl_add_u32 v3, v3, 2, v4
    s_lshl_b32 s48, s3, 2
    v_add_u32 v2, s48, v4
    v_mov_b32 v48, 0
    v_mov_b32 v49, 0
    v_mov_b32 v50, 0
    v_mov_b32 v51, 0
    v_mov_b32 v52, 0
    v_mov_b32 v53, 0
    v_mov_b32 v54, 0
    v_mov_b32 v55, 0
    v_mov_b32 v56, 0
    v_mov_b32 v57, 0
    v_mov_b32 v58, 0
    v_mov_b32 v59, 0
    v_mov_b32 v60, 0
    v_mov_b32 v61, 0
    v_mov_b32 v62, 0
    v_mov_b32 v63, 0
    v_and_b32 v112, 31, v1
    v_lshlrev_b32 v112, 11, v112
    v_lshrrev_b32 v113, 5, v1
    v_lshl_add_u32 v112, v113, 4, v112
    s_lshl_b32 s40, s46, 16
    s_lshl_b32 s49, s47, 8
    s_add_u32 s40, s40, s49
    s_lshl_b32 s49, s3, 6
    s_add_u32 s40, s40, s49
    s_mov_b32 s57, 128
    s_mov_b32 s56, 0
Lpw_7:
    ds_read_b32 v42, v44
    s_add_u32 s56, s56, 1
    s_waitcnt lgkmcnt(0)
    v_cmp_gt_u32 vcc, s57, v42
    s_cbranch_vccz Lpwd_8
    s_cmp_lt_u32 s56, 4000000
    s_cbranch_scc1 Lpw_7
Lpwd_8:
    ds_read_b64_tr_b16 v[188:189], v40 offset:0
    ds_read_b64_tr_b16 v[190:191], v40 offset:2048
    ds_read_b64_tr_b16 v[192:193], v40 offset:4096
    ds_read_b64_tr_b16 v[194:195], v40 offset:6144
    ds_read_b64_tr_b16 v[196:197], v40 offset:8192
    ds_read_b64_tr_b16 v[198:199], v40 offset:10240
    ds_read_b64_tr_b16 v[200:201], v40 offset:12288
    ds_read_b64_tr_b16 v[202:203], v40 offset:14336
    ds_read_b64_tr_b16 v[204:205], v40 offset:16384
    ds_read_b64_tr_b16 v[206:207], v40 offset:18432
    ds_read_b64_tr_b16 v[208:209], v40 offset:20480
    ds_read_b64_tr_b16 v[210:211], v40 offset:22528
    ds_read_b64_tr_b16 v[212:213], v40 offset:24576
    ds_read_b64_tr_b16 v[214:215], v40 offset:26624
    ds_read_b64_tr_b16 v[216:217], v40 offset:28672
    ds_read_b64_tr_b16 v[218:219], v40 offset:30720
    ds_read_b64_tr_b16 v[220:221], v46 offset:0
    ds_read_b64_tr_b16 v[222:223], v46 offset:2048
    ds_read_b64_tr_b16 v[224:225], v46 offset:4096
    ds_read_b64_tr_b16 v[226:227], v46 offset:6144
    ds_read_b64_tr_b16 v[228:229], v46 offset:8192
    ds_read_b64_tr_b16 v[230:231], v46 offset:10240
    ds_read_b64_tr_b16 v[232:233], v46 offset:12288
    ds_read_b64_tr_b16 v[234:235], v46 offset:14336
    ds_read_b64_tr_b16 v[236:237], v46 offset:16384
    ds_read_b64_tr_b16 v[238:239], v46 offset:18432
    ds_read_b64_tr_b16 v[240:241], v46 offset:20480
    ds_read_b64_tr_b16 v[242:243], v46 offset:22528
    ds_read_b64_tr_b16 v[244:245], v46 offset:24576
    ds_read_b64_tr_b16 v[246:247], v46 offset:26624
    ds_read_b64_tr_b16 v[248:249], v46 offset:28672
    ds_read_b64_tr_b16 v[250:251], v46 offset:30720
    ds_read_b64_tr_b16 v[252:253], v46 offset:32768
    ds_read_b64_tr_b16 v[254:255], v46 offset:34816
    s_mov_b32 s54, 0
    s_mov_b32 s58, 0
    s_mov_b32 s56, 0
    s_branch LT_wait
LT_own:
    s_cmp_lg_u32 s58, 0
    s_cbranch_scc1 LT_dma
    s_mov_b64 exec, 0xff
    buffer_load_dword v7, v6, s[32:35], s59 offen sc1
    s_mov_b64 exec, -1
    s_branch LT_oth
LT_dma:
    s_add_u32 m0, s55, 32768
    s_add_u32 s48, s62, 4096
    buffer_load_dwordx4 v43, s[32:35], s62 offen offset:0 sc1 lds
    buffer_load_dwordx4 v43, s[32:35], s62 offen offset:1024 sc1 lds
    buffer_load_dwordx4 v43, s[32:35], s62 offen offset:2048 sc1 lds
    buffer_load_dwordx4 v43, s[32:35], s62 offen offset:3072 sc1 lds
    s_add_u32 m0, m0, 4096
    s_nop 0
    buffer_load_dwordx4 v43, s[32:35], s48 offen offset:0 sc1 lds
    buffer_load_dwordx4 v43, s[32:35], s48 offen offset:1024 sc1 lds
    buffer_load_dwordx4 v43, s[32:35], s48 offen offset:2048 sc1 lds
    buffer_load_dwordx4 v43, s[32:35], s48 offen offset:3072 sc1 lds
LT_oth:
    s_mov_b32 s57, 0
LT_scan:
    ds_read_b32 v42, v3 offset:80
    s_waitcnt lgkmcnt(0)
    v_cmp_ne_u32 vcc, 0, v42
    s_andn2_b32 s48, vcc_lo, s54
    s_and_b32 s48, s48, 15
    s_cbranch_scc0 LT_back
    s_ff1_i32_b32 s63, s48
    s_lshl_b32 s48, s63, 13
    v_add_u32 v5, s48, v43
    ds_read_b128 v[8:11], v5 offset:32768
    ds_read_b128 v[12:15], v5 offset:33792
    ds_read_b128 v[16:19], v5 offset:34816
    ds_read_b128 v[20:23], v5 offset:35840
    ds_read_b128 v[24:27], v5 offset:36864
    ds_read_b128 v[28:31], v5 offset:37888
    ds_read_b128 v[32:35], v5 offset:38912
    ds_read_b128 v[36:39], v5 offset:39936
LT_mul:
    s_bitset1_b32 s54, s63
    s_cmp_lg_u32 s63, 0
    s_cbranch_scc1 LT_g1
    s_waitcnt lgkmcnt(7)
    v_mfma_f32_32x32x16_bf16 v[48:63], v[128:131], v[8:11], v[48:63]
    s_waitcnt lgkmcnt(6)
    v_mfma_f32_32x32x16_bf16 v[48:63], v[132:135], v[12:15], v[48:63]
    s_waitcnt lgkmcnt(5)
    v_mfma_f32_32x32x16_bf16 v[48:63], v[136:139], v[16:19], v[48:63]
    s_waitcnt lgkmcnt(4)
    v_mfma_f32_32x32x16_bf16 v[48:63], v[140:143], v[20:23], v[48:63]
    s_waitcnt lgkmcnt(3)
    v_mfma_f32_32x32x16_bf16 v[48:63], v[144:147], v[24:27], v[48:63]
    s_waitcnt lgkmcnt(2)
    v_mfma_f32_32x32x16_bf16 v[48:63], v[148:151], v[28:31], v[48:63]
    s_waitcnt lgkmcnt(1)
    v_mfma_f32_32x32x16_bf16 v[48:63], v[152:155], v[32:35], v[48:63]
    s_waitcnt lgkmcnt(0)
    v_mfma_f32_32x32x16_bf16 v[48:63], v[156:159], v[36:39], v[48:63]
    s_branch LT_back
LT_g1:
    s_cmp_lg_u32 s63, 1
    s_cbranch_scc1 LT_g2
    s_waitcnt lgkmcnt(7)
    v_mfma_f32_32x32x16_bf16 v[48:63], v[160:163], v[8:11], v[48:63]
    s_waitcnt lgkmcnt(6)
    v_mfma_f32_32x32x16_bf16 v[48:63], v[164:167], v[12:15], v[48:63]
    s_waitcnt lgkmcnt(5)
    v_mfma_f32_32x32x16_bf16 v[48:63], v[168:171], v[16:19], v[48:63]
    s_waitcnt lgkmcnt(4)
    v_mfma_f32_32x32x16_bf16 v[48:63], v[172:175], v[20:23], v[48:63]
    s_waitcnt lgkmcnt(3)
    v_mfma_f32_32x32x16_bf16 v[48:63], v[176:179], v[24:27], v[48:63]
    s_waitcnt lgkmcnt(2)
    v_mfma_f32_32x32x16_bf16 v[48:63], v[180:183], v[28:31], v[48:63]
    s_waitcnt lgkmcnt(1)
    v_mfma_f32_32x32x16_bf16 v[48:63], v[184:187], v[32:35], v[48:63]
    s_waitcnt lgkmcnt(0)
    v_mfma_f32_32x32x16_bf16 v[48:63], v[188:191], v[36:39], v[48:63]
    s_branch LT_back
LT_g2:
    s_cmp_lg_u32 s63, 2
    s_cbranch_scc1 LT_g3
    s_waitcnt lgkmcnt(7)
    v_mfma_f32_32x32x16_bf16 v[48:63], v[192:195], v[8:11], v[48:63]
    s_waitcnt lgkmcnt(6)
    v_mfma_f32_32x32x16_bf16 v[48:63], v[196:199], v[12:15], v[48:63]
    s_waitcnt lgkmcnt(5)
    v_mfma_f32_32x32x16_bf16 v[48:63], v[200:203], v[16:19], v[48:63]
    s_waitcnt lgkmcnt(4)
    v_mfma_f32_32x32x16_bf16 v[48:63], v[204:207], v[20:23], v[48:63]
    s_waitcnt lgkmcnt(3)
    v_mfma_f32_32x32x16_bf16 v[48:63], v[208:211], v[24:27], v[48:63]
    s_waitcnt lgkmcnt(2)
    v_mfma_f32_32x32x16_bf16 v[48:63], v[212:215], v[28:31], v[48:63]
    s_waitcnt lgkmcnt(1)
    v_mfma_f32_32x32x16_bf16 v[48:63], v[216:219], v[32:35], v[48:63]
    s_waitcnt lgkmcnt(0)
    v_mfma_f32_32x32x16_bf16 v[48:63], v[220:223], v[36:39], v[48:63]
    s_branch LT_back
LT_g3:
    s_waitcnt lgkmcnt(7)
    v_mfma_f32_32x32x16_bf16 v[48:63], v[224:227], v[8:11], v[48:63]
    s_waitcnt lgkmcnt(6)
    v_mfma_f32_32x32x16_bf16 v[48:63], v[228:231], v[12:15], v[48:63]
    s_waitcnt lgkmcnt(5)
    v_mfma_f32_32x32x16_bf16 v[48:63], v[232:235], v[16:19], v[48:63]
    s_waitcnt lgkmcnt(4)
    v_mfma_f32_32x32x16_bf16 v[48:63], v[236:239], v[20:23], v[48:63]
    s_waitcnt lgkmcnt(3)
    v_mfma_f32_32x32x16_bf16 v[48:63], v[240:243], v[24:27], v[48:63]
    s_waitcnt lgkmcnt(2)
    v_mfma_f32_32x32x16_bf16 v[48:63], v[244:247], v[28:31], v[48:63]
    s_waitcnt lgkmcnt(1)
    v_mfma_f32_32x32x16_bf16 v[48:63], v[248:251], v[32:35], v[48:63]
    s_waitcnt lgkmcnt(0)
    v_mfma_f32_32x32x16_bf16 v[48:63], v[252:255], v[36:39], v[48:63]
LT_back:
    s_cmp_lg_u32 s57, 0
    s_cbranch_scc1 LT_rest
LT_wait:
    s_add_u32 s56, s56, 1
    s_cmp_ge_u32 s56, 400000
    s_cselect_b32 s49, 1, 0
    s_waitcnt vmcnt(0)
    s_cmp_lg_u32 s58, 0
    s_cbranch_scc1 LT_chk
    s_mov_b64 exec, 0xff
    v_cmp_ne_u32 vcc, s36, v7
    s_mov_b64 exec, -1
    s_cmp_eq_u32 vcc_lo, 0
    s_cselect_b32 s58, 1, s49
    s_branch LT_own
LT_chk:
    v_add_u32 v5, s55, v43
    ds_read_b128 v[8:11], v5 offset:32768
    ds_read_b128 v[12:15], v5 offset:33792
    ds_read_b128 v[16:19], v5 offset:34816
    ds_read_b128 v[20:23], v5 offset:35840
    ds_read_b128 v[24:27], v5 offset:36864
    ds_read_b128 v[28:31], v5 offset:37888
    ds_read_b128 v[32:35], v5 offset:38912
    ds_read_b128 v[36:39], v5 offset:39936
    s_waitcnt lgkmcnt(7)
    v_max3_u32 v41, v8, v11, v8
    s_waitcnt lgkmcnt(6)
    v_max3_u32 v41, v12, v15, v41
    s_waitcnt lgkmcnt(5)
    v_max3_u32 v41, v16, v19, v41
    s_waitcnt lgkmcnt(4)
    v_max3_u32 v41, v20, v23, v41
    s_waitcnt lgkmcnt(3)
    v_max3_u32 v41, v24, v27, v41
    s_waitcnt lgkmcnt(2)
    v_max3_u32 v41, v28, v31, v41
    s_waitcnt lgkmcnt(1)
    v_max3_u32 v41, v32, v35, v41
    s_waitcnt lgkmcnt(0)
    v_max3_u32 v41, v36, v39, v41
    v_cmp_eq_u32 vcc, -1, v41
    s_cmp_lg_u32 s49, 0
    s_cbranch_scc1 LT_ok
    s_cbranch_vccnz LT_own
LT_ok:
    s_mov_b64 exec, 1
    ds_write_b32 v2, v4 offset:80
    s_mov_b64 exec, -1
    s_mov_b32 s63, s3
    s_mov_b32 s57, 1
    s_mov_b32 s56, 0
    s_branch LT_mul
LT_rest:
    s_add_u32 s56, s56, 1
    s_cmp_ge_u32 s56, 4000000
    s_cbranch_scc1 LT_end
    s_cmp_lg_u32 s54, 15
    s_cbranch_scc1 LT_scan
LT_end:
    s_nop 6
    v_cvt_pk_bf16_f32 v8, v48, v49
    v_cvt_pk_bf16_f32 v9, v50, v51
    v_cvt_pk_bf16_f32 v10, v52, v53
    v_cvt_pk_bf16_f32 v11, v54, v55
    v_cvt_pk_bf16_f32 v12, v56, v57
    v_cvt_pk_bf16_f32 v13, v58, v59
    v_cvt_pk_bf16_f32 v14, v60, v61
    v_cvt_pk_bf16_f32 v15, v62, v63
    s_nop 1
    v_permlane32_swap_b32 v8, v10
    v_permlane32_swap_b32 v9, v11
    v_permlane32_swap_b32 v12, v14
    v_permlane32_swap_b32 v13, v15
    buffer_store_dwordx4 v[8:11], v112, s[28:31], s40 offen nt
    buffer_store_dwordx4 v[12:15], v112, s[28:31], s40 offen offset:32 nt
    s_or_b32 s48, s2, s3
    s_cmp_lg_u32 s48, 0
    s_cbranch_scc1 LA_end
    s_mov_b32 s48, 0
    s_mov_b64 exec, 1
    v_mov_b32 v16, 0
    v_mov_b32 v17, s36
    buffer_store_dword v17, v16, s[32:35], s48 offen sc1
    s_mov_b64 exec, -1
LA_end:
    s_endpgm
LA_pre:
    s_mov_b32 s63, 2
    ds_read_b32 v45, v44
    s_waitcnt lgkmcnt(0)
    v_cmp_gt_u32 vcc, 64, v45
    s_cbranch_vccnz LA_attn
    ds_read_b64_tr_b16 v[128:129], v46 offset:0
    ds_read_b64_tr_b16 v[130:131], v46 offset:2048
    ds_read_b64_tr_b16 v[132:133], v46 offset:4096
    ds_read_b64_tr_b16 v[134:135], v46 offset:6144
    ds_read_b64_tr_b16 v[136:137], v46 offset:8192
    ds_read_b64_tr_b16 v[138:139], v46 offset:10240
    ds_read_b64_tr_b16 v[140:141], v46 offset:12288
    ds_read_b64_tr_b16 v[142:143], v46 offset:14336
    ds_read_b64_tr_b16 v[144:145], v46 offset:16384
    ds_read_b64_tr_b16 v[146:147], v46 offset:18432
    ds_read_b64_tr_b16 v[148:149], v46 offset:20480
    ds_read_b64_tr_b16 v[150:151], v46 offset:22528
    ds_read_b64_tr_b16 v[152:153], v46 offset:24576
    ds_read_b64_tr_b16 v[154:155], v46 offset:26624
    ds_read_b64_tr_b16 v[156:157], v46 offset:28672
    ds_read_b64_tr_b16 v[158:159], v46 offset:30720
    ds_read_b64_tr_b16 v[160:161], v46 offset:32768
    ds_read_b64_tr_b16 v[162:163], v46 offset:34816
    ds_read_b64_tr_b16 v[164:165], v46 offset:36864
    ds_read_b64_tr_b16 v[166:167], v46 offset:38912
    ds_read_b64_tr_b16 v[168:169], v46 offset:40960
    ds_read_b64_tr_b16 v[170:171], v46 offset:43008
    ds_read_b64_tr_b16 v[172:173], v46 offset:45056
    ds_read_b64_tr_b16 v[174:175], v46 offset:47104
    ds_read_b64_tr_b16 v[176:177], v46 offset:49152
    ds_read_b64_tr_b16 v[178:179], v46 offset:51200
    ds_read_b64_tr_b16 v[180:181], v46 offset:53248
    ds_read_b64_tr_b16 v[182:183], v46 offset:55296
    ds_read_b64_tr_b16 v[184:185], v46 offset:57344
    ds_read_b64_tr_b16 v[186:187], v46 offset:59392
    v_mov_b32 v45, 1
    s_waitcnt lgkmcnt(0)
    s_mov_b64 exec, 1
    ds_add_u32 v4, v45 offset:44
    s_mov_b64 exec, -1
    s_mov_b32 s63, 1
    s_branch LA_attn
LA_pre2:
    s_mov_b32 s63, 0
    ds_read_b32 v45, v44
    s_waitcnt lgkmcnt(0)
    v_cmp_gt_u32 vcc, 64, v45
    s_cbranch_vccnz LA_pre2d
    ds_read_b64_tr_b16 v[128:129], v46 offset:0
    ds_read_b64_tr_b16 v[130:131], v46 offset:2048
    ds_read_b64_tr_b16 v[132:133], v46 offset:4096
    ds_read_b64_tr_b16 v[134:135], v46 offset:6144
    ds_read_b64_tr_b16 v[136:137], v46 offset:8192
    ds_read_b64_tr_b16 v[138:139], v46 offset:10240
    ds_read_b64_tr_b16 v[140:141], v46 offset:12288
    ds_read_b64_tr_b16 v[142:143], v46 offset:14336
    ds_read_b64_tr_b16 v[144:145], v46 offset:16384
    ds_read_b64_tr_b16 v[146:147], v46 offset:18432
    ds_read_b64_tr_b16 v[148:149], v46 offset:20480
    ds_read_b64_tr_b16 v[150:151], v46 offset:22528
    ds_read_b64_tr_b16 v[152:153], v46 offset:24576
    ds_read_b64_tr_b16 v[154:155], v46 offset:26624
    ds_read_b64_tr_b16 v[156:157], v46 offset:28672
    ds_read_b64_tr_b16 v[158:159], v46 offset:30720
    ds_read_b64_tr_b16 v[160:161], v46 offset:32768
    ds_read_b64_tr_b16 v[162:163], v46 offset:34816
    ds_read_b64_tr_b16 v[164:165], v46 offset:36864
    ds_read_b64_tr_b16 v[166:167], v46 offset:38912
    ds_read_b64_tr_b16 v[168:169], v46 offset:40960
    ds_read_b64_tr_b16 v[170:171], v46 offset:43008
    ds_read_b64_tr_b16 v[172:173], v46 offset:45056
    ds_read_b64_tr_b16 v[174:175], v46 offset:47104
    ds_read_b64_tr_b16 v[176:177], v46 offset:49152
    ds_read_b64_tr_b16 v[178:179], v46 offset:51200
    ds_read_b64_tr_b16 v[180:181], v46 offset:53248
    ds_read_b64_tr_b16 v[182:183], v46 offset:55296
    ds_read_b64_tr_b16 v[184:185], v46 offset:57344
    ds_read_b64_tr_b16 v[186:187], v46 offset:59392
    v_mov_b32 v45, 1
    s_waitcnt lgkmcnt(0)
    s_mov_b64 exec, 1
    ds_add_u32 v4, v45 offset:44
    s_mov_b64 exec, -1
    s_mov_b32 s63, 1
    s_branch LA_pre2d
LA_hint:
    s_mov_b64 exec, 1
    buffer_store_dword v117, v116, s[32:35], s98 offen sc1
    s_mov_b64 exec, -1
    s_branch LA_hinted
LA_stall:
    s_mov_b32 s56, 0
Lpw_9:
    ds_read_b32 v42, v3
    s_add_u32 s56, s56, 1
    s_waitcnt lgkmcnt(0)
    v_cmp_gt_u32 vcc, s57, v42
    s_cbranch_vccz Lpwd_10
    s_cmp_lt_u32 s56, 4000000
    s_cbranch_scc1 Lpw_9
Lpwd_10:
    s_branch LA_resume
LA_fallback:
    s_mov_b32 s59, 1
    s_waitcnt vmcnt(0)
    v_mov_b32 v112, 0xff800000
    v_mov_b32 v113, 0xff800000
    s_lshl_b32 s50, s44, 16
    s_add_u32 s50, s50, 3145728
    s_mov_b32 s54, 0
LF_max:
    buffer_load_dwordx4 v[16:19], v43, s[32:35], s50 offen sc1
    s_add_u32 s50, s50, 1024
    s_waitcnt vmcnt(0)
    v_mfma_f32_32x32x16_bf16 v[48:63], v[16:19], v[8:11], 0
    v_mfma_f32_32x32x16_bf16 v[64:79], v[16:19], v[12:15], 0
    s_nop 7
    s_nop 7
    v_max3_f32 v112, v112, v48, v49
    v_max3_f32 v112, v112, v50, v51
    v_max3_f32 v112, v112, v52, v53
    v_max3_f32 v112, v112, v54, v55
    v_max3_f32 v112, v112, v56, v57
    v_max3_f32 v112, v112, v58, v59
    v_max3_f32 v112, v112, v60, v61
    v_max3_f32 v112, v112, v62, v63
    v_max3_f32 v113, v113, v64, v65
    v_max3_f32 v113, v113, v66, v67
    v_max3_f32 v113, v113, v68, v69
    v_max3_f32 v113, v113, v70, v71
    v_max3_f32 v113, v113, v72, v73
    v_max3_f32 v113, v113, v74, v75
    v_max3_f32 v113, v113, v76, v77
    v_max3_f32 v113, v113, v78, v79
    s_add_u32 s54, s54, 1
    s_cmp_lt_u32 s54, 64
    s_cbranch_scc1 LF_max
    v_mov_b32 v114, v112
    s_nop 1
    v_permlane32_swap_b32 v114, v112
    s_nop 1
    v_max_f32 v112, v114, v112
    v_mov_b32 v114, v113
    s_nop 1
    v_permlane32_swap_b32 v114, v113
    s_nop 1
    v_max_f32 v113, v114, v113
    v_mov_b32 v80, 0
    v_mov_b32 v81, 0
    v_mov_b32 v82, 0
    v_mov_b32 v83, 0
    v_mov_b32 v84, 0
    v_mov_b32 v85, 0
    v_mov_b32 v86, 0
    v_mov_b32 v87, 0
    v_mov_b32 v88, 0
    v_mov_b32 v89, 0
    v_mov_b32 v90, 0
    v_mov_b32 v91, 0
    v_mov_b32 v92, 0
    v_mov_b32 v93, 0
    v_mov_b32 v94, 0
    v_mov_b32 v95, 0
    v_mov_b32 v96, 0
    v_mov_b32 v97, 0
    v_mov_b32 v98, 0
    v_mov_b32 v99, 0
    v_mov_b32 v100, 0
    v_mov_b32 v101, 0
    v_mov_b32 v102, 0
    v_mov_b32 v103, 0
    v_mov_b32 v104, 0
    v_mov_b32 v105, 0
    v_mov_b32 v106, 0
    v_mov_b32 v107, 0
    v_mov_b32 v108, 0
    v_mov_b32 v109, 0
    v_mov_b32 v110, 0
    v_mov_b32 v111, 0
    s_sub_u32 s50, s50, 65536
    s_mov_b32 s54, 0
LF_pv:
    buffer_load_dwordx4 v[16:19], v43, s[32:35], s50 offen sc1
    s_add_u32 s51, s50, 2097152
    s_mov_b64 exec, s[60:61]
    buffer_load_dwordx4 v[24:27], v43, s[32:35], s51 offen sc1
    buffer_load_dwordx4 v[28:31], v43, s[32:35], s51 offen offset:256 sc1
    s_mov_b64 exec, -1
    s_add_u32 s50, s50, 1024
    s_waitcnt vmcnt(0)
    v_mfma_f32_32x32x16_bf16 v[48:63], v[16:19], v[8:11], 0
    v_mfma_f32_32x32x16_bf16 v[64:79], v[16:19], v[12:15], 0
    s_nop 7
    s_nop 7
    v_sub_f32 v48, v48, v112
    v_sub_f32 v49, v49, v112
    v_sub_f32 v50, v50, v112
    v_sub_f32 v51, v51, v112
    v_sub_f32 v52, v52, v112
    v_sub_f32 v53, v53, v112
    v_sub_f32 v54, v54, v112
    v_sub_f32 v55, v55, v112
    v_sub_f32 v56, v56, v112
    v_sub_f32 v57, v57, v112
    v_sub_f32 v58, v58, v112
    v_sub_f32 v59, v59, v112
    v_sub_f32 v60, v60, v112
    v_sub_f32 v61, v61, v112
    v_sub_f32 v62, v62, v112
    v_sub_f32 v63, v63, v112
    v_sub_f32 v64, v64, v113
    v_sub_f32 v65, v65, v113
    v_sub_f32 v66, v66, v113
    v_sub_f32 v67, v67, v113
    v_sub_f32 v68, v68, v113
    v_sub_f32 v69, v69, v113
    v_sub_f32 v70, v70, v113
    v_sub_f32 v71, v71, v113
    v_sub_f32 v72, v72, v113
    v_sub_f32 v73, v73, v113
    v_sub_f32 v74, v74, v113
    v_sub_f32 v75, v75, v113
    v_sub_f32 v76, v76, v113
    v_sub_f32 v77, v77, v113
    v_sub_f32 v78, v78, v113
    v_sub_f32 v79, v79, v113
    v_exp_f32 v48, v48
    v_exp_f32 v49, v49
    v_exp_f32 v50, v50
    v_exp_f32 v51, v51
    v_exp_f32 v52, v52
    v_exp_f32 v53, v53
    v_exp_f32 v54, v54
    v_exp_f32 v55, v55
    v_exp_f32 v56, v56
    v_exp_f32 v57, v57
    v_exp_f32 v58, v58
    v_exp_f32 v59, v59
    v_exp_f32 v60, v60
    v_exp_f32 v61, v61
    v_exp_f32 v62, v62
    v_exp_f32 v63, v63
    v_exp_f32 v64, v64
    v_exp_f32 v65, v65
    v_exp_f32 v66, v66
    v_exp_f32 v67, v67
    v_exp_f32 v68, v68
    v_exp_f32 v69, v69
    v_exp_f32 v70, v70
    v_exp_f32 v71, v71
    v_exp_f32 v72, v72
    v_exp_f32 v73, v73
    v_exp_f32 v74, v74
    v_exp_f32 v75, v75
    v_exp_f32 v76, v76
    v_exp_f32 v77, v77
    v_exp_f32 v78, v78
    v_exp_f32 v79, v79
    s_nop 1
    v_smfmac_f32_32x32x32_bf16 v[80:95], v[24:27], v[48:55], v5
    v_smfmac_f32_32x32x32_bf16 v[80:95], v[28:31], v[56:63], v5
    v_smfmac_f32_32x32x32_bf16 v[96:111], v[24:27], v[64:71], v5
    v_smfmac_f32_32x32x32_bf16 v[96:111], v[28:31], v[72:79], v5
    s_add_u32 s54, s54, 1
    s_cmp_lt_u32 s54, 64
    s_cbranch_scc1 LF_pv
    s_nop 7
    s_nop 7
    s_branch LA_fin
L_helper:
    v_readfirstlane_b32 s36, v7
    s_add_u32 s36, s36, 2654435761
    v_mov_b32 v124, 163584
    v_lshrrev_b32 v8, 2, v1
    v_mul_u32_u24 v8, 3072, v8
    v_and_b32 v9, 3, v1
    v_lshl_add_u32 v122, v9, 4, v8
    s_lshl_b32 s60, s42, 17
    s_lshl_b32 s48, s3, 15
    s_add_u32 s60, s60, s48
    s_mul_i32 s61, s3, 49152
    s_lshl_b32 s48, s43, 6
    s_add_u32 s61, s61, s48
    s_lshl_b32 s59, s3, 12
    v_and_b32 v8, 31, v1
    v_lshlrev_b32 v9, 7, v8
    v_add_u32 v9, s59, v9
    v_bfe_u32 v10, v1, 1, 3
    v_lshrrev_b32 v11, 5, v1
    v_xor_b32 v10, v10, v11
    v_xor_b32 v12, 0, v10
    v_lshl_add_u32 v40, v12, 4, v9
    v_xor_b32 v12, 2, v10
    v_lshl_add_u32 v41, v12, 4, v9
    v_xor_b32 v12, 4, v10
    v_lshl_add_u32 v42, v12, 4, v9
    v_xor_b32 v12, 6, v10
    v_lshl_add_u32 v43, v12, 4, v9
    v_bfe_u32 v12, v1, 2, 2
    v_lshl_add_u32 v12, v11, 3, v12
    v_bfe_u32 v13, v1, 4, 1
    v_and_b32 v14, 3, v1
    v_lshlrev_b32 v14, 3, v14
    v_lshl_add_u32 v14, v13, 5, v14
    v_lshl_add_u32 v44, v12, 6, v14
    v_mov_b32 v48, 0x358637bd
    v_mov_b32 v49, 0x358637bd
    v_mov_b32 v50, 0x358637bd
    v_mov_b32 v51, 0x358637bd
    v_mov_b32 v52, 0x358637bd
    v_mov_b32 v53, 0x358637bd
    v_mov_b32 v54, 0x358637bd
    v_mov_b32 v55, 0x358637bd
    v_mov_b32 v56, 0x358637bd
    v_mov_b32 v57, 0x358637bd
    v_mov_b32 v58, 0x358637bd
    v_mov_b32 v59, 0x358637bd
    v_mov_b32 v60, 0x358637bd
    v_mov_b32 v61, 0x358637bd
    v_mov_b32 v62, 0x358637bd
    v_mov_b32 v63, 0x358637bd
    v_mov_b32 v64, 0x358637bd
    v_mov_b32 v65, 0x358637bd
    v_mov_b32 v66, 0x358637bd
    v_mov_b32 v67, 0x358637bd
    v_mov_b32 v68, 0x358637bd
    v_mov_b32 v69, 0x358637bd
    v_mov_b32 v70, 0x358637bd
    v_mov_b32 v71, 0x358637bd
    v_mov_b32 v72, 0x358637bd
    v_mov_b32 v73, 0x358637bd
    v_mov_b32 v74, 0x358637bd
    v_mov_b32 v75, 0x358637bd
    v_mov_b32 v76, 0x358637bd
    v_mov_b32 v77, 0x358637bd
    v_mov_b32 v78, 0x358637bd
    v_mov_b32 v79, 0x358637bd
    v_mov_b32 v80, 0
    v_mov_b32 v81, 0
    v_mov_b32 v82, 0
    v_mov_b32 v83, 0
    v_mov_b32 v84, 0
    v_mov_b32 v85, 0
    v_mov_b32 v86, 0
    v_mov_b32 v87, 0
    v_mov_b32 v88, 0
    v_mov_b32 v89, 0
    v_mov_b32 v90, 0
    v_mov_b32 v91, 0
    v_mov_b32 v92, 0
    v_mov_b32 v93, 0
    v_mov_b32 v94, 0
    v_mov_b32 v95, 0
    v_lshlrev_b32 v107, 4, v1
    s_lshl_b32 s48, s3, 8
    s_add_u32 s48, s48, 162560
    v_lshlrev_b32 v108, 2, v1
    v_add_u32 v108, s48, v108
    v_and_b32 v109, 3, v1
    v_lshlrev_b32 v109, 8, v109
    v_add_u32 v109, 161536, v109
    s_lshl_b32 s96, s3, 11
    s_lshl_b32 s55, s3, 12
    s_mul_i32 s97, s3, 3072
    s_add_u32 s97, s97, 16384
    s_lshl_b32 s58, s44, 16
    s_lshl_b32 s48, s3, 11
    s_add_u32 s58, s58, s48
    s_add_u32 s58, s58, 3145728
    v_mov_b32 v96, -1
    v_mov_b32 v97, -1
    v_mov_b32 v98, -1
    v_mov_b32 v99, -1
    s_lshl_b32 s62, s39, 1
    s_add_u32 s62, s62, s38
    v_lshrrev_b32 v8, 4, v1
    v_lshlrev_b32 v104, 2, v8
    v_and_b32 v105, 15, v1
    v_xor_b32 v104, v104, v105
    v_lshlrev_b32 v104, 4, v104
    v_lshl_add_u32 v104, v8, 10, v104
    v_bfe_u32 v8, v1, 2, 2
    v_xor_b32 v105, s3, v8
    v_lshlrev_b32 v105, 6, v105
    v_lshl_add_u32 v105, v8, 8, v105
    v_lshrrev_b32 v8, 5, v1
    v_lshl_add_u32 v105, v8, 10, v105
    v_bfe_u32 v8, v1, 4, 1
    v_lshl_add_u32 v105, v8, 5, v105
    v_and_b32 v8, 3, v1
    v_lshl_add_u32 v105, v8, 3, v105
    v_add_u32 v105, 65536, v105
    v_lshlrev_b32 v106, 7, v1
    v_mov_b32 v111, 1
    v_add_u32 v2, 98304, v40
    v_add_u32 v3, 98304, v41
    v_add_u32 v4, 98304, v42
    v_add_u32 v5, 98304, v43
    v_add_u32 v6, 98304, v44
    s_cmp_lg_u32 s42, 0
    s_cbranch_scc1 LB_nozero
    v_mov_b32 v8, 0
    v_mov_b32 v9, 0
    v_mov_b32 v10, 0
    v_mov_b32 v11, 0
    s_lshl_b32 s48, s43, 12
    s_lshl_b32 s49, s3, 10
    s_add_u32 s48, s48, s49
    s_add_u32 s48, s48, 262144
    buffer_store_dwordx4 v[8:11], v107, s[32:35], s48 offen sc1
    s_lshl_b32 s48, s43, 7
    s_lshl_b32 s49, s3, 15
    s_add_u32 s48, s48, s49
    s_add_u32 s48, s48, 65536
    s_waitcnt vmcnt(0)
    s_mov_b64 exec, 1
    v_mov_b32 v8, 0
    v_mov_b32 v9, s36
    buffer_store_dword v9, v8, s[32:35], s48 offen sc1
    s_mov_b64 exec, -1
LB_nozero:
    s_lshr_b32 s52, s44, 2
    s_lshl_b32 s52, s52, 5
    s_add_u32 s52, s52, s3
    s_lshl_b32 s52, s52, 7
    s_and_b32 s49, s44, 2
    s_lshl_b32 s49, s49, 15
    s_add_u32 s52, s52, s49
    s_add_u32 s52, s52, 12058624
    v_and_b32 v46, 1, v1
    v_lshlrev_b32 v46, 15, v46
    s_setprio 2
    s_mov_b32 s56, 0
Llw_11:
    ds_read_b32 v125, v124 offset:24
    s_add_u32 s56, s56, 1
    s_waitcnt lgkmcnt(0)
    v_readfirstlane_b32 s53, v125
    s_cmp_ge_u32 s53, 4
    s_cbranch_scc1 Llwd_12
    s_sleep 1
    s_cmp_lt_u32 s56, 4000000
    s_cbranch_scc1 Llw_11
Llwd_12:
    s_mov_b32 s98, s45
    v_lshrrev_b32 v47, 1, v1
    v_add_u32 v47, s98, v47
    v_and_b32 v47, 7, v47
    v_lshl_add_u32 v46, v47, 9, v46
    s_mov_b64 exec, 0xc
    s_mov_b32 s56, 0
Lgp_13:
    buffer_load_dword v47, v46, s[32:35], s52 offen sc1
    s_add_u32 s56, s56, 1
    s_waitcnt vmcnt(0)
    v_cmp_ne_u32 vcc, s36, v47
    s_cbranch_vccz Lgpd_14
    s_cmp_lt_u32 s56, 400000
    s_cbranch_scc1 Lgp_13
Lgpd_14:
    s_mov_b64 exec, -1
    s_add_u32 s49, s98, 1
    s_and_b32 s49, s49, 7
    s_lshl_b32 s49, s49, 13
    s_add_u32 m0, s96, 49152
    s_add_u32 s49, s49, s58
    buffer_load_dwordx4 v107, s[32:35], s49 offen offset:0 sc1 lds
    buffer_load_dwordx4 v107, s[32:35], s49 offen offset:1024 sc1 lds
    s_add_u32 m0, s96, 57344
    s_add_u32 s49, s49, 2097152
    buffer_load_dwordx4 v107, s[32:35], s49 offen offset:0 sc1 lds
    buffer_load_dwordx4 v107, s[32:35], s49 offen offset:1024 sc1 lds
    s_mov_b64 exec, 0xfff0
    buffer_load_dword v47, v46, s[32:35], s52 offen sc1
    s_mov_b64 exec, -1
    v_mov_b32 v110, 2
    s_waitcnt vmcnt(1)
    ds_write_b32 v108, v110
    s_mov_b64 exec, 0xfff0
    s_waitcnt vmcnt(0)
    v_cmp_ne_u32 vcc, s36, v47
    s_cbranch_vccz LB_all
    s_mov_b32 s56, 0
Lgp_15:
    buffer_load_dword v47, v46, s[32:35], s52 offen sc1
    s_add_u32 s56, s56, 1
    s_waitcnt vmcnt(0)
    v_cmp_ne_u32 vcc, s36, v47
    s_cbranch_vccz Lgpd_16
    s_sleep 1
    s_cmp_lt_u32 s56, 400000
    s_cbranch_scc1 Lgp_15
Lgpd_16:
LB_all:
    s_mov_b64 exec, -1
    s_add_u32 s49, s98, 2
    s_and_b32 s49, s49, 7
    s_lshl_b32 s49, s49, 13
    s_add_u32 m0, s96, 65536
    s_add_u32 s49, s49, s58
    buffer_load_dwordx4 v107, s[32:35], s49 offen offset:0 sc1 lds
    buffer_load_dwordx4 v107, s[32:35], s49 offen offset:1024 sc1 lds
    s_add_u32 m0, s96, 73728
    s_add_u32 s49, s49, 2097152
    buffer_load_dwordx4 v107, s[32:35], s49 offen offset:0 sc1 lds
    buffer_load_dwordx4 v107, s[32:35], s49 offen offset:1024 sc1 lds
    s_add_u32 s49, s98, 3
    s_and_b32 s49, s49, 7
    s_lshl_b32 s49, s49, 13
    s_add_u32 m0, s96, 81920
    s_add_u32 s49, s49, s58
    buffer_load_dwordx4 v107, s[32:35], s49 offen offset:0 sc1 lds
    buffer_load_dwordx4 v107, s[32:35], s49 offen offset:1024 sc1 lds
    s_add_u32 m0, s96, 90112
    s_add_u32 s49, s49, 2097152
    buffer_load_dwordx4 v107, s[32:35], s49 offen offset:0 sc1 lds
    buffer_load_dwordx4 v107, s[32:35], s49 offen offset:1024 sc1 lds
    s_add_u32 s48, s62, 0
    s_and_b32 s48, s48, 7
    s_add_u32 m0, s97, 98304
    s_mul_i32 s50, s48, 196608
    s_add_u32 s50, s50, s61
    buffer_load_dwordx4 v122, s[20:23], s50 offen lds
    buffer_load_dwordx4 v122, s[20:23], s50 offen offset:1024 lds
    buffer_load_dwordx4 v122, s[20:23], s50 offen offset:2048 lds
    s_add_u32 s48, s62, 0
    s_and_b32 s48, s48, 7
    s_add_u32 m0, s55, 98304
    s_lshl_b32 s49, s48, 7
    s_add_u32 s49, s49, s60
    buffer_load_dwordx4 v120, s[16:19], s49 offen lds
    s_add_u32 m0, m0, 1024
    s_nop 0
    buffer_load_dwordx4 v121, s[16:19], s49 offen lds
    s_add_u32 m0, m0, 1024
    s_add_u32 s49, s49, 16384
    buffer_load_dwordx4 v120, s[16:19], s49 offen lds
    s_add_u32 m0, m0, 1024
    s_nop 0
    buffer_load_dwordx4 v121, s[16:19], s49 offen lds
    v_mov_b32 v110, 4
    s_waitcnt vmcnt(7)
    ds_write_b32 v108, v110
    s_waitcnt vmcnt(0)
    s_mov_b64 exec, 1
    ds_add_u32 v124, v111 offset:0
    s_mov_b64 exec, -1
    ds_read_b32 v46, v124
    s_waitcnt lgkmcnt(0)
    v_cmp_gt_u32 vcc, 4, v46
    s_cbranch_vccz Lck_17
    s_mov_b32 s56, 0
Llw_18:
    ds_read_b32 v125, v124 offset:0
    s_add_u32 s56, s56, 1
    s_waitcnt lgkmcnt(0)
    v_readfirstlane_b32 s53, v125
    s_cmp_ge_u32 s53, 4
    s_cbranch_scc1 Llwd_19
    s_sleep 1
    s_cmp_lt_u32 s56, 4000000
    s_cbranch_scc1 Llw_18
Llwd_19:
Lck_17:
    ds_read_b128 v[8:11], v2 offset:0
    ds_read_b64_tr_b16 v[12:13], v6 offset:16384
    ds_read_b64_tr_b16 v[14:15], v6 offset:16640
    ds_read_b64_tr_b16 v[16:17], v6 offset:17408
    ds_read_b64_tr_b16 v[18:19], v6 offset:17664
    ds_read_b64_tr_b16 v[20:21], v6 offset:18432
    ds_read_b64_tr_b16 v[22:23], v6 offset:18688
    s_setprio 0
    s_waitcnt lgkmcnt(4)
    v_mfma_f32_32x32x16_bf16 v[48:63], v[12:15], v[8:11], v[48:63]
    ds_read_b128 v[24:27], v3 offset:0
    ds_read_b64_tr_b16 v[28:29], v6 offset:19456
    ds_read_b64_tr_b16 v[30:31], v6 offset:19712
    s_add_u32 s48, s62, 1
    s_and_b32 s48, s48, 7
    s_add_u32 m0, s97, 126976
    s_mul_i32 s50, s48, 196608
    s_add_u32 s50, s50, s61
    buffer_load_dwordx4 v122, s[20:23], s50 offen lds
    s_waitcnt lgkmcnt(5)
    v_mfma_f32_32x32x16_bf16 v[64:79], v[8:11], v[16:19], v[64:79]
    ds_read_b64_tr_b16 v[32:33], v6 offset:20480
    ds_read_b64_tr_b16 v[34:35], v6 offset:20736
    buffer_load_dwordx4 v122, s[20:23], s50 offen offset:1024 lds
    s_waitcnt lgkmcnt(5)
    v_mfma_f32_32x32x16_bf16 v[80:95], v[8:11], v[20:23], v[80:95]
    ds_read_b64_tr_b16 v[36:37], v6 offset:21504
    ds_read_b64_tr_b16 v[38:39], v6 offset:21760
    buffer_load_dwordx4 v122, s[20:23], s50 offen offset:2048 lds
    s_waitcnt lgkmcnt(4)
    v_mfma_f32_32x32x16_bf16 v[48:63], v[28:31], v[24:27], v[48:63]
    ds_read_b128 v[8:11], v4 offset:0
    ds_read_b64_tr_b16 v[12:13], v6 offset:22528
    ds_read_b64_tr_b16 v[14:15], v6 offset:22784
    s_add_u32 s48, s62, 1
    s_and_b32 s48, s48, 7
    s_add_u32 m0, s55, 126976
    s_lshl_b32 s49, s48, 7
    s_add_u32 s49, s49, s60
    buffer_load_dwordx4 v120, s[16:19], s49 offen lds
    s_add_u32 m0, m0, 1024
    s_nop 0
    buffer_load_dwordx4 v121, s[16:19], s49 offen lds
    s_add_u32 m0, m0, 1024
    s_add_u32 s49, s49, 16384
    s_waitcnt lgkmcnt(5)
    v_mfma_f32_32x32x16_bf16 v[64:79], v[24:27], v[32:35], v[64:79]
    ds_read_b64_tr_b16 v[16:17], v6 offset:23552
    ds_read_b64_tr_b16 v[18:19], v6 offset:23808
    buffer_load_dwordx4 v120, s[16:19], s49 offen lds
    s_add_u32 m0, m0, 1024
    s_nop 0
    buffer_load_dwordx4 v121, s[16:19], s49 offen lds
    s_waitcnt lgkmcnt(5)
    v_mfma_f32_32x32x16_bf16 v[80:95], v[24:27], v[36:39], v[80:95]
    ds_read_b64_tr_b16 v[20:21], v6 offset:24576
    ds_read_b64_tr_b16 v[22:23], v6 offset:24832
    s_waitcnt lgkmcnt(4)
    v_mfma_f32_32x32x16_bf16 v[48:63], v[12:15], v[8:11], v[48:63]
    ds_read_b128 v[24:27], v5 offset:0
    ds_read_b64_tr_b16 v[28:29], v6 offset:25600
    ds_read_b64_tr_b16 v[30:31], v6 offset:25856
    s_lshl_b32 s48, s45, 2
    s_add_u32 s48, s48, s3
    s_lshl_b32 s48, s48, 16
    s_lshl_b32 s52, s44, 10
    s_add_u32 s48, s48, s52
    s_add_u32 s48, s48, 9437184
    s_add_u32 s52, s48, 32768
    buffer_store_dwordx4 v[96:99], v107, s[32:35], s48 offen sc1
    buffer_store_dwordx4 v[96:99], v107, s[32:35], s52 offen sc1
    s_lshl_b32 s48, s42, 2
    s_add_u32 s48, s48, s3
    s_lshl_b32 s48, s48, 15
    s_lshl_b32 s52, s43, 11
    s_add_u32 s48, s48, s52
    s_add_u32 s63, s48, 7340032
    buffer_store_dwordx4 v[96:99], v107, s[32:35], s63 offen sc1
    buffer_store_dwordx4 v[96:99], v107, s[32:35], s63 offen offset:1024 sc1
    s_waitcnt lgkmcnt(5)
    v_mfma_f32_32x32x16_bf16 v[64:79], v[8:11], v[16:19], v[64:79]
    ds_read_b64_tr_b16 v[32:33], v6 offset:26624
    ds_read_b64_tr_b16 v[34:35], v6 offset:26880
    s_waitcnt lgkmcnt(5)
    v_mfma_f32_32x32x16_bf16 v[80:95], v[8:11], v[20:23], v[80:95]
    ds_read_b64_tr_b16 v[36:37], v6 offset:27648
    ds_read_b64_tr_b16 v[38:39], v6 offset:27904
    s_waitcnt lgkmcnt(4)
    v_mfma_f32_32x32x16_bf16 v[48:63], v[28:31], v[24:27], v[48:63]
    s_waitcnt lgkmcnt(2)
    v_mfma_f32_32x32x16_bf16 v[64:79], v[24:27], v[32:35], v[64:79]
    s_waitcnt lgkmcnt(0)
    v_mfma_f32_32x32x16_bf16 v[80:95], v[24:27], v[36:39], v[80:95]
    s_setprio 2
    s_mov_b64 exec, 1
    ds_add_u32 v124, v111 offset:68
    s_mov_b64 exec, -1
    s_waitcnt vmcnt(4)
    s_mov_b64 exec, 1
    ds_add_u32 v124, v111 offset:0
    s_mov_b64 exec, -1
    s_setprio 2
    ds_read_b32 v46, v124
    s_waitcnt lgkmcnt(0)
    v_cmp_gt_u32 vcc, 8, v46
    s_cbranch_vccz Lck_20
    s_mov_b32 s56, 0
Llw_21:
    ds_read_b32 v125, v124 offset:0
    s_add_u32 s56, s56, 1
    s_waitcnt lgkmcnt(0)
    v_readfirstlane_b32 s53, v125
    s_cmp_ge_u32 s53, 8
    s_cbranch_scc1 Llwd_22
    s_sleep 1
    s_cmp_lt_u32 s56, 4000000
    s_cbranch_scc1 Llw_21
Llwd_22:
Lck_20:
    ds_read_b32 v47, v124 offset:68
    ds_read_b128 v[8:11], v2 offset:28672
    ds_read_b64_tr_b16 v[12:13], v6 offset:45056
    ds_read_b64_tr_b16 v[14:15], v6 offset:45312
    ds_read_b64_tr_b16 v[16:17], v6 offset:46080
    ds_read_b64_tr_b16 v[18:19], v6 offset:46336
    ds_read_b64_tr_b16 v[20:21], v6 offset:47104
    ds_read_b64_tr_b16 v[22:23], v6 offset:47360
    s_setprio 0
    s_waitcnt lgkmcnt(4)
    v_mfma_f32_32x32x16_bf16 v[48:63], v[12:15], v[8:11], v[48:63]
    ds_read_b128 v[24:27], v3 offset:28672
    ds_read_b64_tr_b16 v[28:29], v6 offset:48128
    ds_read_b64_tr_b16 v[30:31], v6 offset:48384
    s_setprio 2
    v_cmp_gt_u32 vcc, 4, v47
    s_cbranch_vccz Lck_23
    s_mov_b32 s56, 0
Llw_24:
    ds_read_b32 v125, v124 offset:68
    s_add_u32 s56, s56, 1
    s_waitcnt lgkmcnt(0)
    v_readfirstlane_b32 s53, v125
    s_cmp_ge_u32 s53, 4
    s_cbranch_scc1 Llwd_25
    s_sleep 1
    s_cmp_lt_u32 s56, 4000000
    s_cbranch_scc1 Llw_24
Llwd_25:
Lck_23:
    s_setprio 0
    s_add_u32 s48, s62, 2
    s_and_b32 s48, s48, 7
    s_add_u32 m0, s97, 98304
    s_mul_i32 s50, s48, 196608
    s_add_u32 s50, s50, s61
    buffer_load_dwordx4 v122, s[20:23], s50 offen lds
    s_waitcnt lgkmcnt(5)
    v_mfma_f32_32x32x16_bf16 v[64:79], v[8:11], v[16:19], v[64:79]
    ds_read_b64_tr_b16 v[32:33], v6 offset:49152
    ds_read_b64_tr_b16 v[34:35], v6 offset:49408
    buffer_load_dwordx4 v122, s[20:23], s50 offen offset:1024 lds
    s_waitcnt lgkmcnt(5)
    v_mfma_f32_32x32x16_bf16 v[80:95], v[8:11], v[20:23], v[80:95]
    ds_read_b64_tr_b16 v[36:37], v6 offset:50176
    ds_read_b64_tr_b16 v[38:39], v6 offset:50432
    buffer_load_dwordx4 v122, s[20:23], s50 offen offset:2048 lds
    s_waitcnt lgkmcnt(4)
    v_mfma_f32_32x32x16_bf16 v[48:63], v[28:31], v[24:27], v[48:63]
    ds_read_b128 v[8:11], v4 offset:28672
    ds_read_b64_tr_b16 v[12:13], v6 offset:51200
    ds_read_b64_tr_b16 v[14:15], v6 offset:51456
    s_add_u32 s48, s62, 2
    s_and_b32 s48, s48, 7
    s_add_u32 m0, s55, 98304
    s_lshl_b32 s49, s48, 7
    s_add_u32 s49, s49, s60
    buffer_load_dwordx4 v120, s[16:19], s49 offen lds
    s_add_u32 m0, m0, 1024
    s_nop 0
    buffer_load_dwordx4 v121, s[16:19], s49 offen lds
    s_add_u32 m0, m0, 1024
    s_add_u32 s49, s49, 16384
    s_waitcnt lgkmcnt(5)
    v_mfma_f32_32x32x16_bf16 v[64:79], v[24:27], v[32:35], v[64:79]
    ds_read_b64_tr_b16 v[16:17], v6 offset:52224
    ds_read_b64_tr_b16 v[18:19], v6 offset:52480
    buffer_load_dwordx4 v120, s[16:19], s49 offen lds
    s_add_u32 m0, m0, 1024
    s_nop 0
    buffer_load_dwordx4 v121, s[16:19], s49 offen lds
    s_waitcnt lgkmcnt(5)
    v_mfma_f32_32x32x16_bf16 v[80:95], v[24:27], v[36:39], v[80:95]
    ds_read_b64_tr_b16 v[20:21], v6 offset:53248
    ds_read_b64_tr_b16 v[22:23], v6 offset:53504
    s_waitcnt lgkmcnt(4)
    v_mfma_f32_32x32x16_bf16 v[48:63], v[12:15], v[8:11], v[48:63]
    ds_read_b128 v[24:27], v5 offset:28672
    ds_read_b64_tr_b16 v[28:29], v6 offset:54272
    ds_read_b64_tr_b16 v[30:31], v6 offset:54528
    s_add_u32 s49, s98, 4
    s_and_b32 s49, s49, 7
    s_lshl_b32 s49, s49, 13
    s_add_u32 m0, s96, 0
    s_add_u32 s49, s49, s58
    buffer_load_dwordx4 v107, s[32:35], s49 offen offset:0 sc1 lds
    buffer_load_dwordx4 v107, s[32:35], s49 offen offset:1024 sc1 lds
    s_waitcnt lgkmcnt(5)
    v_mfma_f32_32x32x16_bf16 v[64:79], v[8:11], v[16:19], v[64:79]
    ds_read_b64_tr_b16 v[32:33], v6 offset:55296
    ds_read_b64_tr_b16 v[34:35], v6 offset:55552
    s_add_u32 m0, s96, 8192
    s_add_u32 s49, s49, 2097152
    buffer_load_dwordx4 v107, s[32:35], s49 offen offset:0 sc1 lds
    buffer_load_dwordx4 v107, s[32:35], s49 offen offset:1024 sc1 lds
    s_waitcnt lgkmcnt(5)
    v_mfma_f32_32x32x16_bf16 v[80:95], v[8:11], v[20:23], v[80:95]
    ds_read_b64_tr_b16 v[36:37], v6 offset:56320
    ds_read_b64_tr_b16 v[38:39], v6 offset:56576
    s_waitcnt lgkmcnt(4)
    v_mfma_f32_32x32x16_bf16 v[48:63], v[28:31], v[24:27], v[48:63]
    s_waitcnt lgkmcnt(2)
    v_mfma_f32_32x32x16_bf16 v[64:79], v[24:27], v[32:35], v[64:79]
    s_waitcnt lgkmcnt(0)
    v_mfma_f32_32x32x16_bf16 v[80:95], v[24:27], v[36:39], v[80:95]
    s_setprio 2
    s_mov_b64 exec, 1
    ds_add_u32 v124, v111 offset:68
    s_mov_b64 exec, -1
    s_waitcnt vmcnt(4)
    s_mov_b64 exec, 1
    ds_add_u32 v124, v111 offset:0
    s_mov_b64 exec, -1
    s_setprio 2
    ds_read_b32 v46, v124
    s_waitcnt lgkmcnt(0)
    v_cmp_gt_u32 vcc, 12, v46
    s_cbranch_vccz Lck_26
    s_mov_b32 s56, 0
Llw_27:
    ds_read_b32 v125, v124 offset:0
    s_add_u32 s56, s56, 1
    s_waitcnt lgkmcnt(0)
    v_readfirstlane_b32 s53, v125
    s_cmp_ge_u32 s53, 12
    s_cbranch_scc1 Llwd_28
    s_sleep 1
    s_cmp_lt_u32 s56, 4000000
    s_cbranch_scc1 Llw_27
Llwd_28:
Lck_26:
    ds_read_b32 v47, v124 offset:68
    ds_read_b128 v[8:11], v2 offset:0
    ds_read_b64_tr_b16 v[12:13], v6 offset:16384
    ds_read_b64_tr_b16 v[14:15], v6 offset:16640
    ds_read_b64_tr_b16 v[16:17], v6 offset:17408
    ds_read_b64_tr_b16 v[18:19], v6 offset:17664
    ds_read_b64_tr_b16 v[20:21], v6 offset:18432
    ds_read_b64_tr_b16 v[22:23], v6 offset:18688
    s_setprio 0
    s_waitcnt lgkmcnt(4)
    v_mfma_f32_32x32x16_bf16 v[48:63], v[12:15], v[8:11], v[48:63]
    ds_read_b128 v[24:27], v3 offset:0
    ds_read_b64_tr_b16 v[28:29], v6 offset:19456
    ds_read_b64_tr_b16 v[30:31], v6 offset:19712
    s_setprio 2
    v_cmp_gt_u32 vcc, 8, v47
    s_cbranch_vccz Lck_29
    s_mov_b32 s56, 0
Llw_30:
    ds_read_b32 v125, v124 offset:68
    s_add_u32 s56, s56, 1
    s_waitcnt lgkmcnt(0)
    v_readfirstlane_b32 s53, v125
    s_cmp_ge_u32 s53, 8
    s_cbranch_scc1 Llwd_31
    s_sleep 1
    s_cmp_lt_u32 s56, 4000000
    s_cbranch_scc1 Llw_30
Llwd_31:
Lck_29:
    v_mov_b32 v110, 5
    s_setprio 0
    s_add_u32 s48, s62, 3
    s_and_b32 s48, s48, 7
    s_add_u32 m0, s97, 126976
    s_mul_i32 s50, s48, 196608
    s_add_u32 s50, s50, s61
    buffer_load_dwordx4 v122, s[20:23], s50 offen lds
    s_waitcnt lgkmcnt(5)
    v_mfma_f32_32x32x16_bf16 v[64:79], v[8:11], v[16:19], v[64:79]
    ds_read_b64_tr_b16 v[32:33], v6 offset:20480
    ds_read_b64_tr_b16 v[34:35], v6 offset:20736
    buffer_load_dwordx4 v122, s[20:23], s50 offen offset:1024 lds
    s_waitcnt lgkmcnt(5)
    v_mfma_f32_32x32x16_bf16 v[80:95], v[8:11], v[20:23], v[80:95]
    ds_read_b64_tr_b16 v[36:37], v6 offset:21504
    ds_read_b64_tr_b16 v[38:39], v6 offset:21760
    buffer_load_dwordx4 v122, s[20:23], s50 offen offset:2048 lds
    s_waitcnt lgkmcnt(4)
    v_mfma_f32_32x32x16_bf16 v[48:63], v[28:31], v[24:27], v[48:63]
    ds_read_b128 v[8:11], v4 offset:0
    ds_read_b64_tr_b16 v[12:13], v6 offset:22528
    ds_read_b64_tr_b16 v[14:15], v6 offset:22784
    s_add_u32 s48, s62, 3
    s_and_b32 s48, s48, 7
    s_add_u32 m0, s55, 126976
    s_lshl_b32 s49, s48, 7
    s_add_u32 s49, s49, s60
    buffer_load_dwordx4 v120, s[16:19], s49 offen lds
    s_add_u32 m0, m0, 1024
    s_nop 0
    buffer_load_dwordx4 v121, s[16:19], s49 offen lds
    s_add_u32 m0, m0, 1024
    s_add_u32 s49, s49, 16384
    s_waitcnt lgkmcnt(5)
    v_mfma_f32_32x32x16_bf16 v[64:79], v[24:27], v[32:35], v[64:79]
    ds_read_b64_tr_b16 v[16:17], v6 offset:23552
    ds_read_b64_tr_b16 v[18:19], v6 offset:23808
    buffer_load_dwordx4 v120, s[16:19], s49 offen lds
    s_add_u32 m0, m0, 1024
    s_nop 0
    buffer_load_dwordx4 v121, s[16:19], s49 offen lds
    s_waitcnt lgkmcnt(5)
    v_mfma_f32_32x32x16_bf16 v[80:95], v[24:27], v[36:39], v[80:95]
    ds_read_b64_tr_b16 v[20:21], v6 offset:24576
    ds_read_b64_tr_b16 v[22:23], v6 offset:24832
    s_waitcnt lgkmcnt(4)
    v_mfma_f32_32x32x16_bf16 v[48:63], v[12:15], v[8:11], v[48:63]
    ds_read_b128 v[24:27], v5 offset:0
    ds_read_b64_tr_b16 v[28:29], v6 offset:25600
    ds_read_b64_tr_b16 v[30:31], v6 offset:25856
    s_add_u32 s49, s98, 5
    s_and_b32 s49, s49, 7
    s_lshl_b32 s49, s49, 13
    s_add_u32 m0, s96, 16384
    s_add_u32 s49, s49, s58
    buffer_load_dwordx4 v107, s[32:35], s49 offen offset:0 sc1 lds
    buffer_load_dwordx4 v107, s[32:35], s49 offen offset:1024 sc1 lds
    s_waitcnt lgkmcnt(5)
    v_mfma_f32_32x32x16_bf16 v[64:79], v[8:11], v[16:19], v[64:79]
    ds_read_b64_tr_b16 v[32:33], v6 offset:26624
    ds_read_b64_tr_b16 v[34:35], v6 offset:26880
    s_add_u32 m0, s96, 24576
    s_add_u32 s49, s49, 2097152
    buffer_load_dwordx4 v107, s[32:35], s49 offen offset:0 sc1 lds
    buffer_load_dwordx4 v107, s[32:35], s49 offen offset:1024 sc1 lds
    s_waitcnt lgkmcnt(5)
    v_mfma_f32_32x32x16_bf16 v[80:95], v[8:11], v[20:23], v[80:95]
    ds_read_b64_tr_b16 v[36:37], v6 offset:27648
    ds_read_b64_tr_b16 v[38:39], v6 offset:27904
    s_waitcnt lgkmcnt(4)
    v_mfma_f32_32x32x16_bf16 v[48:63], v[28:31], v[24:27], v[48:63]
    s_waitcnt lgkmcnt(2)
    v_mfma_f32_32x32x16_bf16 v[64:79], v[24:27], v[32:35], v[64:79]
    s_waitcnt lgkmcnt(0)
    v_mfma_f32_32x32x16_bf16 v[80:95], v[24:27], v[36:39], v[80:95]
    s_setprio 2
    s_mov_b64 exec, 1
    ds_add_u32 v124, v111 offset:68
    s_mov_b64 exec, -1
    s_waitcnt vmcnt(4)
    ds_write_b32 v108, v110
    s_mov_b64 exec, 1
    ds_add_u32 v124, v111 offset:0
    s_mov_b64 exec, -1
    s_setprio 2
    ds_read_b32 v46, v124
    s_waitcnt lgkmcnt(0)
    v_cmp_gt_u32 vcc, 16, v46
    s_cbranch_vccz Lck_32
    s_mov_b32 s56, 0
Llw_33:
    ds_read_b32 v125, v124 offset:0
    s_add_u32 s56, s56, 1
    s_waitcnt lgkmcnt(0)
    v_readfirstlane_b32 s53, v125
    s_cmp_ge_u32 s53, 16
    s_cbranch_scc1 Llwd_34
    s_sleep 1
    s_cmp_lt_u32 s56, 4000000
    s_cbranch_scc1 Llw_33
Llwd_34:
Lck_32:
    ds_read_b32 v47, v124 offset:68
    ds_read_b32 v45, v109
    ds_read_b128 v[8:11], v2 offset:28672
    ds_read_b64_tr_b16 v[12:13], v6 offset:45056
    ds_read_b64_tr_b16 v[14:15], v6 offset:45312
    ds_read_b64_tr_b16 v[16:17], v6 offset:46080
    ds_read_b64_tr_b16 v[18:19], v6 offset:46336
    ds_read_b64_tr_b16 v[20:21], v6 offset:47104
    ds_read_b64_tr_b16 v[22:23], v6 offset:47360
    s_setprio 0
    s_waitcnt lgkmcnt(4)
    v_mfma_f32_32x32x16_bf16 v[48:63], v[12:15], v[8:11], v[48:63]
    ds_read_b128 v[24:27], v3 offset:28672
    ds_read_b64_tr_b16 v[28:29], v6 offset:48128
    ds_read_b64_tr_b16 v[30:31], v6 offset:48384
    s_setprio 2
    v_cmp_gt_u32 vcc, 12, v47
    s_cbranch_vccz Lck_35
    s_mov_b32 s56, 0
Llw_36:
    ds_read_b32 v125, v124 offset:68
    s_add_u32 s56, s56, 1
    s_waitcnt lgkmcnt(0)
    v_readfirstlane_b32 s53, v125
    s_cmp_ge_u32 s53, 12
    s_cbranch_scc1 Llwd_37
    s_sleep 1
    s_cmp_lt_u32 s56, 4000000
    s_cbranch_scc1 Llw_36
Llwd_37:
Lck_35:
    v_cmp_gt_u32 vcc, 3, v45
    s_cbranch_vccz Lck_38
    s_mov_b32 s56, 0
Lpw_39:
    ds_read_b32 v125, v109
    s_add_u32 s56, s56, 1
    s_waitcnt lgkmcnt(0)
    v_cmp_gt_u32 vcc, 3, v125
    s_cbranch_vccz Lpwd_40
    s_sleep 2
    s_cmp_lt_u32 s56, 4000000
    s_cbranch_scc1 Lpw_39
Lpwd_40:
Lck_38:
    v_mov_b32 v110, 6
    s_setprio 0
    s_add_u32 s48, s62, 4
    s_and_b32 s48, s48, 7
    s_add_u32 m0, s97, 98304
    s_mul_i32 s50, s48, 196608
    s_add_u32 s50, s50, s61
    buffer_load_dwordx4 v122, s[20:23], s50 offen lds
    s_waitcnt lgkmcnt(5)
    v_mfma_f32_32x32x16_bf16 v[64:79], v[8:11], v[16:19], v[64:79]
    ds_read_b64_tr_b16 v[32:33], v6 offset:49152
    ds_read_b64_tr_b16 v[34:35], v6 offset:49408
    buffer_load_dwordx4 v122, s[20:23], s50 offen offset:1024 lds
    s_waitcnt lgkmcnt(5)
    v_mfma_f32_32x32x16_bf16 v[80:95], v[8:11], v[20:23], v[80:95]
    ds_read_b64_tr_b16 v[36:37], v6 offset:50176
    ds_read_b64_tr_b16 v[38:39], v6 offset:50432
    buffer_load_dwordx4 v122, s[20:23], s50 offen offset:2048 lds
    s_waitcnt lgkmcnt(4)
    v_mfma_f32_32x32x16_bf16 v[48:63], v[28:31], v[24:27], v[48:63]
    ds_read_b128 v[8:11], v4 offset:28672
    ds_read_b64_tr_b16 v[12:13], v6 offset:51200
    ds_read_b64_tr_b16 v[14:15], v6 offset:51456
    s_add_u32 s48, s62, 4
    s_and_b32 s48, s48, 7
    s_add_u32 m0, s55, 98304
    s_lshl_b32 s49, s48, 7
    s_add_u32 s49, s49, s60
    buffer_load_dwordx4 v120, s[16:19], s49 offen lds
    s_add_u32 m0, m0, 1024
    s_nop 0
    buffer_load_dwordx4 v121, s[16:19], s49 offen lds
    s_add_u32 m0, m0, 1024
    s_add_u32 s49, s49, 16384
    s_waitcnt lgkmcnt(5)
    v_mfma_f32_32x32x16_bf16 v[64:79], v[24:27], v[32:35], v[64:79]
    ds_read_b64_tr_b16 v[16:17], v6 offset:52224
    ds_read_b64_tr_b16 v[18:19], v6 offset:52480
    buffer_load_dwordx4 v120, s[16:19], s49 offen lds
    s_add_u32 m0, m0, 1024
    s_nop 0
    buffer_load_dwordx4 v121, s[16:19], s49 offen lds
    s_waitcnt lgkmcnt(5)
    v_mfma_f32_32x32x16_bf16 v[80:95], v[24:27], v[36:39], v[80:95]
    ds_read_b64_tr_b16 v[20:21], v6 offset:53248
    ds_read_b64_tr_b16 v[22:23], v6 offset:53504
    s_waitcnt lgkmcnt(4)
    v_mfma_f32_32x32x16_bf16 v[48:63], v[12:15], v[8:11], v[48:63]
    ds_read_b128 v[24:27], v5 offset:28672
    ds_read_b64_tr_b16 v[28:29], v6 offset:54272
    ds_read_b64_tr_b16 v[30:31], v6 offset:54528
    s_add_u32 s49, s98, 6
    s_and_b32 s49, s49, 7
    s_lshl_b32 s49, s49, 13
    s_add_u32 m0, s96, 32768
    s_add_u32 s49, s49, s58
    buffer_load_dwordx4 v107, s[32:35], s49 offen offset:0 sc1 lds
    buffer_load_dwordx4 v107, s[32:35], s49 offen offset:1024 sc1 lds
    s_waitcnt lgkmcnt(5)
    v_mfma_f32_32x32x16_bf16 v[64:79], v[8:11], v[16:19], v[64:79]
    ds_read_b64_tr_b16 v[32:33], v6 offset:55296
    ds_read_b64_tr_b16 v[34:35], v6 offset:55552
    s_add_u32 m0, s96, 40960
    s_add_u32 s49, s49, 2097152
    buffer_load_dwordx4 v107, s[32:35], s49 offen offset:0 sc1 lds
    buffer_load_dwordx4 v107, s[32:35], s49 offen offset:1024 sc1 lds
    s_waitcnt lgkmcnt(5)
    v_mfma_f32_32x32x16_bf16 v[80:95], v[8:11], v[20:23], v[80:95]
    ds_read_b64_tr_b16 v[36:37], v6 offset:56320
    ds_read_b64_tr_b16 v[38:39], v6 offset:56576
    s_waitcnt lgkmcnt(4)
    v_mfma_f32_32x32x16_bf16 v[48:63], v[28:31], v[24:27], v[48:63]
    s_waitcnt lgkmcnt(2)
    v_mfma_f32_32x32x16_bf16 v[64:79], v[24:27], v[32:35], v[64:79]
    s_waitcnt lgkmcnt(0)
    v_mfma_f32_32x32x16_bf16 v[80:95], v[24:27], v[36:39], v[80:95]
    s_setprio 2
    s_mov_b64 exec, 1
    ds_add_u32 v124, v111 offset:68
    s_mov_b64 exec, -1
    s_waitcnt vmcnt(4)
    ds_write_b32 v108, v110
    s_mov_b64 exec, 1
    ds_add_u32 v124, v111 offset:0
    s_mov_b64 exec, -1
    s_setprio 2
    ds_read_b32 v46, v124
    s_waitcnt lgkmcnt(0)
    v_cmp_gt_u32 vcc, 20, v46
    s_cbranch_vccz Lck_41
    s_mov_b32 s56, 0
Llw_42:
    ds_read_b32 v125, v124 offset:0
    s_add_u32 s56, s56, 1
    s_waitcnt lgkmcnt(0)
    v_readfirstlane_b32 s53, v125
    s_cmp_ge_u32 s53, 20
    s_cbranch_scc1 Llwd_43
    s_sleep 1
    s_cmp_lt_u32 s56, 4000000
    s_cbranch_scc1 Llw_42
Llwd_43:
Lck_41:
    ds_read_b32 v47, v124 offset:68
    ds_read_b128 v[8:11], v2 offset:0
    ds_read_b64_tr_b16 v[12:13], v6 offset:16384
    ds_read_b64_tr_b16 v[14:15], v6 offset:16640
    ds_read_b64_tr_b16 v[16:17], v6 offset:17408
    ds_read_b64_tr_b16 v[18:19], v6 offset:17664
    ds_read_b64_tr_b16 v[20:21], v6 offset:18432
    ds_read_b64_tr_b16 v[22:23], v6 offset:18688
    s_setprio 0
    s_waitcnt lgkmcnt(4)
    v_mfma_f32_32x32x16_bf16 v[48:63], v[12:15], v[8:11], v[48:63]
    ds_read_b128 v[24:27], v3 offset:0
    ds_read_b64_tr_b16 v[28:29], v6 offset:19456
    ds_read_b64_tr_b16 v[30:31], v6 offset:19712
    s_setprio 2
    v_cmp_gt_u32 vcc, 16, v47
    s_cbranch_vccz Lck_44
    s_mov_b32 s56, 0
Llw_45:
    ds_read_b32 v125, v124 offset:68
    s_add_u32 s56, s56, 1
    s_waitcnt lgkmcnt(0)
    v_readfirstlane_b32 s53, v125
    s_cmp_ge_u32 s53, 16
    s_cbranch_scc1 Llwd_46
    s_sleep 1
    s_cmp_lt_u32 s56, 4000000
    s_cbranch_scc1 Llw_45
Llwd_46:
Lck_44:
    v_mov_b32 v110, 7
    s_setprio 0
    s_add_u32 s48, s62, 5
    s_and_b32 s48, s48, 7
    s_add_u32 m0, s97, 126976
    s_mul_i32 s50, s48, 196608
    s_add_u32 s50, s50, s61
    buffer_load_dwordx4 v122, s[20:23], s50 offen lds
    s_waitcnt lgkmcnt(5)
    v_mfma_f32_32x32x16_bf16 v[64:79], v[8:11], v[16:19], v[64:79]
    ds_read_b64_tr_b16 v[32:33], v6 offset:20480
    ds_read_b64_tr_b16 v[34:35], v6 offset:20736
    buffer_load_dwordx4 v122, s[20:23], s50 offen offset:1024 lds
    s_waitcnt lgkmcnt(5)
    v_mfma_f32_32x32x16_bf16 v[80:95], v[8:11], v[20:23], v[80:95]
    ds_read_b64_tr_b16 v[36:37], v6 offset:21504
    ds_read_b64_tr_b16 v[38:39], v6 offset:21760
    buffer_load_dwordx4 v122, s[20:23], s50 offen offset:2048 lds
    s_waitcnt lgkmcnt(4)
    v_mfma_f32_32x32x16_bf16 v[48:63], v[28:31], v[24:27], v[48:63]
    ds_read_b128 v[8:11], v4 offset:0
    ds_read_b64_tr_b16 v[12:13], v6 offset:22528
    ds_read_b64_tr_b16 v[14:15], v6 offset:22784
    s_add_u32 s48, s62, 5
    s_and_b32 s48, s48, 7
    s_add_u32 m0, s55, 126976
    s_lshl_b32 s49, s48, 7
    s_add_u32 s49, s49, s60
    buffer_load_dwordx4 v120, s[16:19], s49 offen lds
    s_add_u32 m0, m0, 1024
    s_nop 0
    buffer_load_dwordx4 v121, s[16:19], s49 offen lds
    s_add_u32 m0, m0, 1024
    s_add_u32 s49, s49, 16384
    s_waitcnt lgkmcnt(5)
    v_mfma_f32_32x32x16_bf16 v[64:79], v[24:27], v[32:35], v[64:79]
    ds_read_b64_tr_b16 v[16:17], v6 offset:23552
    ds_read_b64_tr_b16 v[18:19], v6 offset:23808
    buffer_load_dwordx4 v120, s[16:19], s49 offen lds
    s_add_u32 m0, m0, 1024
    s_nop 0
    buffer_load_dwordx4 v121, s[16:19], s49 offen lds
    s_waitcnt lgkmcnt(5)
    v_mfma_f32_32x32x16_bf16 v[80:95], v[24:27], v[36:39], v[80:95]
    ds_read_b64_tr_b16 v[20:21], v6 offset:24576
    ds_read_b64_tr_b16 v[22:23], v6 offset:24832
    s_waitcnt lgkmcnt(4)
    v_mfma_f32_32x32x16_bf16 v[48:63], v[12:15], v[8:11], v[48:63]
    ds_read_b128 v[24:27], v5 offset:0
    ds_read_b64_tr_b16 v[28:29], v6 offset:25600
    ds_read_b64_tr_b16 v[30:31], v6 offset:25856
    s_lshr_b32 s48, s2, 3
    s_lshl_b32 s48, s48, 14
    s_add_u32 s48, s48, s55
    s_mov_b32 exec_hi, 0
    buffer_load_dword v118, v106, s[24:27], s48 offen sc1
    buffer_load_dword v119, v106, s[12:15], s48 offen sc1
    s_mov_b32 exec_hi, -1
    s_waitcnt lgkmcnt(5)
    v_mfma_f32_32x32x16_bf16 v[64:79], v[8:11], v[16:19], v[64:79]
    ds_read_b64_tr_b16 v[32:33], v6 offset:26624
    ds_read_b64_tr_b16 v[34:35], v6 offset:26880
    s_waitcnt lgkmcnt(5)
    v_mfma_f32_32x32x16_bf16 v[80:95], v[8:11], v[20:23], v[80:95]
    ds_read_b64_tr_b16 v[36:37], v6 offset:27648
    ds_read_b64_tr_b16 v[38:39], v6 offset:27904
    s_waitcnt lgkmcnt(4)
    v_mfma_f32_32x32x16_bf16 v[48:63], v[28:31], v[24:27], v[48:63]
    s_waitcnt lgkmcnt(2)
    v_mfma_f32_32x32x16_bf16 v[64:79], v[24:27], v[32:35], v[64:79]
    s_waitcnt lgkmcnt(0)
    v_mfma_f32_32x32x16_bf16 v[80:95], v[24:27], v[36:39], v[80:95]
    s_setprio 2
    s_mov_b64 exec, 1
    ds_add_u32 v124, v111 offset:68
    s_mov_b64 exec, -1
    s_waitcnt vmcnt(2)
    ds_write_b32 v108, v110
    s_mov_b64 exec, 1
    ds_add_u32 v124, v111 offset:0
    s_mov_b64 exec, -1
    s_setprio 2
    ds_read_b32 v46, v124
    s_waitcnt lgkmcnt(0)
    v_cmp_gt_u32 vcc, 24, v46
    s_cbranch_vccz Lck_47
    s_mov_b32 s56, 0
Llw_48:
    ds_read_b32 v125, v124 offset:0
    s_add_u32 s56, s56, 1
    s_waitcnt lgkmcnt(0)
    v_readfirstlane_b32 s53, v125
    s_cmp_ge_u32 s53, 24
    s_cbranch_scc1 Llwd_49
    s_sleep 1
    s_cmp_lt_u32 s56, 4000000
    s_cbranch_scc1 Llw_48
Llwd_49:
Lck_47:
    ds_read_b32 v47, v124 offset:68
    ds_read_b32 v45, v109
    ds_read_b128 v[8:11], v2 offset:28672
    ds_read_b64_tr_b16 v[12:13], v6 offset:45056
    ds_read_b64_tr_b16 v[14:15], v6 offset:45312
    ds_read_b64_tr_b16 v[16:17], v6 offset:46080
    ds_read_b64_tr_b16 v[18:19], v6 offset:46336
    ds_read_b64_tr_b16 v[20:21], v6 offset:47104
    ds_read_b64_tr_b16 v[22:23], v6 offset:47360
    s_setprio 0
    s_waitcnt lgkmcnt(4)
    v_mfma_f32_32x32x16_bf16 v[48:63], v[12:15], v[8:11], v[48:63]
    ds_read_b128 v[24:27], v3 offset:28672
    ds_read_b64_tr_b16 v[28:29], v6 offset:48128
    ds_read_b64_tr_b16 v[30:31], v6 offset:48384
    s_setprio 2
    v_cmp_gt_u32 vcc, 20, v47
    s_cbranch_vccz Lck_50
    s_mov_b32 s56, 0
Llw_51:
    ds_read_b32 v125, v124 offset:68
    s_add_u32 s56, s56, 1
    s_waitcnt lgkmcnt(0)
    v_readfirstlane_b32 s53, v125
    s_cmp_ge_u32 s53, 20
    s_cbranch_scc1 Llwd_52
    s_sleep 1
    s_cmp_lt_u32 s56, 4000000
    s_cbranch_scc1 Llw_51
Llwd_52:
Lck_50:
    v_cmp_gt_u32 vcc, 4, v45
    s_cbranch_vccz Lck_53
    s_mov_b32 s56, 0
Lpw_54:
    ds_read_b32 v125, v109
    s_add_u32 s56, s56, 1
    s_waitcnt lgkmcnt(0)
    v_cmp_gt_u32 vcc, 4, v125
    s_cbranch_vccz Lpwd_55
    s_sleep 2
    s_cmp_lt_u32 s56, 4000000
    s_cbranch_scc1 Lpw_54
Lpwd_55:
Lck_53:
    s_setprio 0
    s_add_u32 s48, s62, 6
    s_and_b32 s48, s48, 7
    s_add_u32 m0, s97, 98304
    s_mul_i32 s50, s48, 196608
    s_add_u32 s50, s50, s61
    buffer_load_dwordx4 v122, s[20:23], s50 offen lds
    s_waitcnt lgkmcnt(5)
    v_mfma_f32_32x32x16_bf16 v[64:79], v[8:11], v[16:19], v[64:79]
    ds_read_b64_tr_b16 v[32:33], v6 offset:49152
    ds_read_b64_tr_b16 v[34:35], v6 offset:49408
    buffer_load_dwordx4 v122, s[20:23], s50 offen offset:1024 lds
    s_waitcnt lgkmcnt(5)
    v_mfma_f32_32x32x16_bf16 v[80:95], v[8:11], v[20:23], v[80:95]
    ds_read_b64_tr_b16 v[36:37], v6 offset:50176
    ds_read_b64_tr_b16 v[38:39], v6 offset:50432
    buffer_load_dwordx4 v122, s[20:23], s50 offen offset:2048 lds
    s_waitcnt lgkmcnt(4)
    v_mfma_f32_32x32x16_bf16 v[48:63], v[28:31], v[24:27], v[48:63]
    ds_read_b128 v[8:11], v4 offset:28672
    ds_read_b64_tr_b16 v[12:13], v6 offset:51200
    ds_read_b64_tr_b16 v[14:15], v6 offset:51456
    s_add_u32 s48, s62, 6
    s_and_b32 s48, s48, 7
    s_add_u32 m0, s55, 98304
    s_lshl_b32 s49, s48, 7
    s_add_u32 s49, s49, s60
    buffer_load_dwordx4 v120, s[16:19], s49 offen lds
    s_add_u32 m0, m0, 1024
    s_nop 0
    buffer_load_dwordx4 v121, s[16:19], s49 offen lds
    s_add_u32 m0, m0, 1024
    s_add_u32 s49, s49, 16384
    s_waitcnt lgkmcnt(5)
    v_mfma_f32_32x32x16_bf16 v[64:79], v[24:27], v[32:35], v[64:79]
    ds_read_b64_tr_b16 v[16:17], v6 offset:52224
    ds_read_b64_tr_b16 v[18:19], v6 offset:52480
    buffer_load_dwordx4 v120, s[16:19], s49 offen lds
    s_add_u32 m0, m0, 1024
    s_nop 0
    buffer_load_dwordx4 v121, s[16:19], s49 offen lds
    s_waitcnt lgkmcnt(5)
    v_mfma_f32_32x32x16_bf16 v[80:95], v[24:27], v[36:39], v[80:95]
    ds_read_b64_tr_b16 v[20:21], v6 offset:53248
    ds_read_b64_tr_b16 v[22:23], v6 offset:53504
    s_waitcnt lgkmcnt(4)
    v_mfma_f32_32x32x16_bf16 v[48:63], v[12:15], v[8:11], v[48:63]
    ds_read_b128 v[24:27], v5 offset:28672
    ds_read_b64_tr_b16 v[28:29], v6 offset:54272
    ds_read_b64_tr_b16 v[30:31], v6 offset:54528
    s_add_u32 s49, s98, 7
    s_and_b32 s49, s49, 7
    s_lshl_b32 s49, s49, 13
    s_add_u32 m0, s96, 49152
    s_add_u32 s49, s49, s58
    buffer_load_dwordx4 v107, s[32:35], s49 offen offset:0 sc1 lds
    buffer_load_dwordx4 v107, s[32:35], s49 offen offset:1024 sc1 lds
    s_waitcnt lgkmcnt(5)
    v_mfma_f32_32x32x16_bf16 v[64:79], v[8:11], v[16:19], v[64:79]
    ds_read_b64_tr_b16 v[32:33], v6 offset:55296
    ds_read_b64_tr_b16 v[34:35], v6 offset:55552
    s_add_u32 m0, s96, 57344
    s_add_u32 s49, s49, 2097152
    buffer_load_dwordx4 v107, s[32:35], s49 offen offset:0 sc1 lds
    buffer_load_dwordx4 v107, s[32:35], s49 offen offset:1024 sc1 lds
    s_waitcnt lgkmcnt(5)
    v_mfma_f32_32x32x16_bf16 v[80:95], v[8:11], v[20:23], v[80:95]
    ds_read_b64_tr_b16 v[36:37], v6 offset:56320
    ds_read_b64_tr_b16 v[38:39], v6 offset:56576
    s_waitcnt lgkmcnt(4)
    v_mfma_f32_32x32x16_bf16 v[48:63], v[28:31], v[24:27], v[48:63]
    s_waitcnt lgkmcnt(2)
    v_mfma_f32_32x32x16_bf16 v[64:79], v[24:27], v[32:35], v[64:79]
    s_waitcnt lgkmcnt(0)
    v_mfma_f32_32x32x16_bf16 v[80:95], v[24:27], v[36:39], v[80:95]
    s_setprio 2
    s_mov_b64 exec, 1
    ds_add_u32 v124, v111 offset:68
    s_mov_b64 exec, -1
    s_waitcnt vmcnt(4)
    s_mov_b64 exec, 1
    ds_add_u32 v124, v111 offset:0
    s_mov_b64 exec, -1
    s_setprio 2
    ds_read_b32 v46, v124
    s_waitcnt lgkmcnt(0)
    v_cmp_gt_u32 vcc, 28, v46
    s_cbranch_vccz Lck_56
    s_mov_b32 s56, 0
Llw_57:
    ds_read_b32 v125, v124 offset:0
    s_add_u32 s56, s56, 1
    s_waitcnt lgkmcnt(0)
    v_readfirstlane_b32 s53, v125
    s_cmp_ge_u32 s53, 28
    s_cbranch_scc1 Llwd_58
    s_sleep 1
    s_cmp_lt_u32 s56, 4000000
    s_cbranch_scc1 Llw_57
Llwd_58:
Lck_56:
    ds_read_b32 v47, v124 offset:68
    ds_read_b128 v[8:11], v2 offset:0
    ds_read_b64_tr_b16 v[12:13], v6 offset:16384
    ds_read_b64_tr_b16 v[14:15], v6 offset:16640
    ds_read_b64_tr_b16 v[16:17], v6 offset:17408
    ds_read_b64_tr_b16 v[18:19], v6 offset:17664
    ds_read_b64_tr_b16 v[20:21], v6 offset:18432
    ds_read_b64_tr_b16 v[22:23], v6 offset:18688
    s_setprio 0
    s_waitcnt lgkmcnt(4)
    v_mfma_f32_32x32x16_bf16 v[48:63], v[12:15], v[8:11], v[48:63]
    ds_read_b128 v[24:27], v3 offset:0
    ds_read_b64_tr_b16 v[28:29], v6 offset:19456
    ds_read_b64_tr_b16 v[30:31], v6 offset:19712
    s_setprio 2
    v_cmp_gt_u32 vcc, 24, v47
    s_cbranch_vccz Lck_59
    s_mov_b32 s56, 0
Llw_60:
    ds_read_b32 v125, v124 offset:68
    s_add_u32 s56, s56, 1
    s_waitcnt lgkmcnt(0)
    v_readfirstlane_b32 s53, v125
    s_cmp_ge_u32 s53, 24
    s_cbranch_scc1 Llwd_61
    s_sleep 1
    s_cmp_lt_u32 s56, 4000000
    s_cbranch_scc1 Llw_60
Llwd_61:
Lck_59:
    v_mov_b32 v110, 9
    s_setprio 0
    s_add_u32 s48, s62, 7
    s_and_b32 s48, s48, 7
    s_add_u32 m0, s97, 126976
    s_mul_i32 s50, s48, 196608
    s_add_u32 s50, s50, s61
    buffer_load_dwordx4 v122, s[20:23], s50 offen lds
    s_waitcnt lgkmcnt(5)
    v_mfma_f32_32x32x16_bf16 v[64:79], v[8:11], v[16:19], v[64:79]
    ds_read_b64_tr_b16 v[32:33], v6 offset:20480
    ds_read_b64_tr_b16 v[34:35], v6 offset:20736
    buffer_load_dwordx4 v122, s[20:23], s50 offen offset:1024 lds
    s_waitcnt lgkmcnt(5)
    v_mfma_f32_32x32x16_bf16 v[80:95], v[8:11], v[20:23], v[80:95]
    ds_read_b64_tr_b16 v[36:37], v6 offset:21504
    ds_read_b64_tr_b16 v[38:39], v6 offset:21760
    buffer_load_dwordx4 v122, s[20:23], s50 offen offset:2048 lds
    s_waitcnt lgkmcnt(4)
    v_mfma_f32_32x32x16_bf16 v[48:63], v[28:31], v[24:27], v[48:63]
    ds_read_b128 v[8:11], v4 offset:0
    ds_read_b64_tr_b16 v[12:13], v6 offset:22528
    ds_read_b64_tr_b16 v[14:15], v6 offset:22784
    s_add_u32 s48, s62, 7
    s_and_b32 s48, s48, 7
    s_add_u32 m0, s55, 126976
    s_lshl_b32 s49, s48, 7
    s_add_u32 s49, s49, s60
    buffer_load_dwordx4 v120, s[16:19], s49 offen lds
    s_add_u32 m0, m0, 1024
    s_nop 0
    buffer_load_dwordx4 v121, s[16:19], s49 offen lds
    s_add_u32 m0, m0, 1024
    s_add_u32 s49, s49, 16384
    s_waitcnt lgkmcnt(5)
    v_mfma_f32_32x32x16_bf16 v[64:79], v[24:27], v[32:35], v[64:79]
    ds_read_b64_tr_b16 v[16:17], v6 offset:23552
    ds_read_b64_tr_b16 v[18:19], v6 offset:23808
    buffer_load_dwordx4 v120, s[16:19], s49 offen lds
    s_add_u32 m0, m0, 1024
    s_nop 0
    buffer_load_dwordx4 v121, s[16:19], s49 offen lds
    s_waitcnt lgkmcnt(5)
    v_mfma_f32_32x32x16_bf16 v[80:95], v[24:27], v[36:39], v[80:95]
    ds_read_b64_tr_b16 v[20:21], v6 offset:24576
    ds_read_b64_tr_b16 v[22:23], v6 offset:24832
    s_waitcnt lgkmcnt(4)
    v_mfma_f32_32x32x16_bf16 v[48:63], v[12:15], v[8:11], v[48:63]
    ds_read_b128 v[24:27], v5 offset:0
    ds_read_b64_tr_b16 v[28:29], v6 offset:25600
    ds_read_b64_tr_b16 v[30:31], v6 offset:25856
    s_waitcnt lgkmcnt(5)
    v_mfma_f32_32x32x16_bf16 v[64:79], v[8:11], v[16:19], v[64:79]
    ds_read_b64_tr_b16 v[32:33], v6 offset:26624
    ds_read_b64_tr_b16 v[34:35], v6 offset:26880
    s_waitcnt lgkmcnt(5)
    v_mfma_f32_32x32x16_bf16 v[80:95], v[8:11], v[20:23], v[80:95]
    ds_read_b64_tr_b16 v[36:37], v6 offset:27648
    ds_read_b64_tr_b16 v[38:39], v6 offset:27904
    s_waitcnt lgkmcnt(4)
    v_mfma_f32_32x32x16_bf16 v[48:63], v[28:31], v[24:27], v[48:63]
    s_waitcnt lgkmcnt(2)
    v_mfma_f32_32x32x16_bf16 v[64:79], v[24:27], v[32:35], v[64:79]
    s_waitcnt lgkmcnt(0)
    v_mfma_f32_32x32x16_bf16 v[80:95], v[24:27], v[36:39], v[80:95]
    s_setprio 2
    s_mov_b64 exec, 1
    ds_add_u32 v124, v111 offset:68
    s_mov_b64 exec, -1
    s_waitcnt vmcnt(0)
    ds_write_b32 v108, v110
    s_mov_b64 exec, 1
    ds_add_u32 v124, v111 offset:0
    s_mov_b64 exec, -1
    s_setprio 2
    ds_read_b32 v46, v124
    s_waitcnt lgkmcnt(0)
    v_cmp_gt_u32 vcc, 32, v46
    s_cbranch_vccz Lck_62
    s_mov_b32 s56, 0
Llw_63:
    ds_read_b32 v125, v124 offset:0
    s_add_u32 s56, s56, 1
    s_waitcnt lgkmcnt(0)
    v_readfirstlane_b32 s53, v125
    s_cmp_ge_u32 s53, 32
    s_cbranch_scc1 Llwd_64
    s_sleep 1
    s_cmp_lt_u32 s56, 4000000
    s_cbranch_scc1 Llw_63
Llwd_64:
Lck_62:
    ds_read_b32 v47, v124 offset:68
    ds_read_b128 v[8:11], v2 offset:28672
    ds_read_b64_tr_b16 v[12:13], v6 offset:45056
    ds_read_b64_tr_b16 v[14:15], v6 offset:45312
    ds_read_b64_tr_b16 v[16:17], v6 offset:46080
    ds_read_b64_tr_b16 v[18:19], v6 offset:46336
    ds_read_b64_tr_b16 v[20:21], v6 offset:47104
    ds_read_b64_tr_b16 v[22:23], v6 offset:47360
    s_setprio 0
    s_waitcnt lgkmcnt(4)
    v_mfma_f32_32x32x16_bf16 v[48:63], v[12:15], v[8:11], v[48:63]
    ds_read_b128 v[24:27], v3 offset:28672
    ds_read_b64_tr_b16 v[28:29], v6 offset:48128
    ds_read_b64_tr_b16 v[30:31], v6 offset:48384
    s_setprio 2
    v_cmp_gt_u32 vcc, 28, v47
    s_cbranch_vccz Lck_65
    s_mov_b32 s56, 0
Llw_66:
    ds_read_b32 v125, v124 offset:68
    s_add_u32 s56, s56, 1
    s_waitcnt lgkmcnt(0)
    v_readfirstlane_b32 s53, v125
    s_cmp_ge_u32 s53, 28
    s_cbranch_scc1 Llwd_67
    s_sleep 1
    s_cmp_lt_u32 s56, 4000000
    s_cbranch_scc1 Llw_66
Llwd_67:
Lck_65:
    s_setprio 0
    s_waitcnt lgkmcnt(5)
    v_mfma_f32_32x32x16_bf16 v[64:79], v[8:11], v[16:19], v[64:79]
    ds_read_b64_tr_b16 v[32:33], v6 offset:49152
    ds_read_b64_tr_b16 v[34:35], v6 offset:49408
    s_waitcnt lgkmcnt(5)
    v_mfma_f32_32x32x16_bf16 v[80:95], v[8:11], v[20:23], v[80:95]
    ds_read_b64_tr_b16 v[36:37], v6 offset:50176
    ds_read_b64_tr_b16 v[38:39], v6 offset:50432
    s_waitcnt lgkmcnt(4)
    v_mfma_f32_32x32x16_bf16 v[48:63], v[28:31], v[24:27], v[48:63]
    ds_read_b128 v[8:11], v4 offset:28672
    ds_read_b64_tr_b16 v[12:13], v6 offset:51200
    ds_read_b64_tr_b16 v[14:15], v6 offset:51456
    s_waitcnt lgkmcnt(5)
    v_mfma_f32_32x32x16_bf16 v[64:79], v[24:27], v[32:35], v[64:79]
    ds_read_b64_tr_b16 v[16:17], v6 offset:52224
    ds_read_b64_tr_b16 v[18:19], v6 offset:52480
    s_waitcnt lgkmcnt(5)
    v_mfma_f32_32x32x16_bf16 v[80:95], v[24:27], v[36:39], v[80:95]
    ds_read_b64_tr_b16 v[20:21], v6 offset:53248
    ds_read_b64_tr_b16 v[22:23], v6 offset:53504
    s_waitcnt lgkmcnt(4)
    v_mfma_f32_32x32x16_bf16 v[48:63], v[12:15], v[8:11], v[48:63]
    ds_read_b128 v[24:27], v5 offset:28672
    ds_read_b64_tr_b16 v[28:29], v6 offset:54272
    ds_read_b64_tr_b16 v[30:31], v6 offset:54528
    s_waitcnt lgkmcnt(5)
    v_mfma_f32_32x32x16_bf16 v[64:79], v[8:11], v[16:19], v[64:79]
    ds_read_b64_tr_b16 v[32:33], v6 offset:55296
    ds_read_b64_tr_b16 v[34:35], v6 offset:55552
    s_waitcnt lgkmcnt(5)
    v_mfma_f32_32x32x16_bf16 v[80:95], v[8:11], v[20:23], v[80:95]
    ds_read_b64_tr_b16 v[36:37], v6 offset:56320
    ds_read_b64_tr_b16 v[38:39], v6 offset:56576
    s_waitcnt lgkmcnt(4)
    v_mfma_f32_32x32x16_bf16 v[48:63], v[28:31], v[24:27], v[48:63]
    s_waitcnt lgkmcnt(2)
    v_mfma_f32_32x32x16_bf16 v[64:79], v[24:27], v[32:35], v[64:79]
    s_waitcnt lgkmcnt(0)
    v_mfma_f32_32x32x16_bf16 v[80:95], v[24:27], v[36:39], v[80:95]
    s_setprio 2
    s_mov_b32 s56, 0
Lpw_68:
    ds_read_b32 v125, v109
    s_add_u32 s56, s56, 1
    s_waitcnt lgkmcnt(0)
    v_cmp_gt_u32 vcc, 6, v125
    s_cbranch_vccz Lpwd_69
    s_sleep 2
    s_cmp_lt_u32 s56, 4000000
    s_cbranch_scc1 Lpw_68
Lpwd_69:
    s_mul_i32 s51, s3, 8192
    s_add_u32 m0, s51, 65536
    s_lshl_b32 s48, s51, 2
    s_lshl_b32 s51, s47, 8
    s_add_u32 s48, s48, s51
    s_add_u32 s52, s48, 32768
Lwr_70:
    buffer_load_dwordx4 v104, s[24:27], s48 offen lds
    s_add_u32 m0, m0, 1024
    s_add_u32 s48, s48, 4096
    s_cmp_lt_u32 s48, s52
    s_cbranch_scc1 Lwr_70
    s_mov_b32 s57, 0x3fb8aa3b
    s_mov_b32 s60, 0x358637bd
    v_mov_b32 v44, 0xb5c1a2a0
    v_and_b32 v45, 3, v1
    v_lshlrev_b32 v45, 15, v45
    s_lshl_b32 s59, s43, 7
    s_add_u32 s59, s59, 65536
    buffer_load_dword v46, v45, s[32:35], s59 offen sc1
    s_nop 7
    v_fma_f32 v8, v64, s57, v44
    v_fma_f32 v9, v65, s57, v44
    v_fma_f32 v10, v66, s57, v44
    v_fma_f32 v11, v67, s57, v44
    v_fma_f32 v12, v68, s57, v44
    v_fma_f32 v13, v69, s57, v44
    v_fma_f32 v14, v70, s57, v44
    v_fma_f32 v15, v71, s57, v44
    v_fma_f32 v16, v72, s57, v44
    v_fma_f32 v17, v73, s57, v44
    v_fma_f32 v18, v74, s57, v44
    v_fma_f32 v19, v75, s57, v44
    v_fma_f32 v20, v76, s57, v44
    v_fma_f32 v21, v77, s57, v44
    v_fma_f32 v22, v78, s57, v44
    v_fma_f32 v23, v79, s57, v44
    v_exp_f32_e64 v8, v8 clamp
    v_exp_f32_e64 v9, v9 clamp
    v_exp_f32_e64 v10, v10 clamp
    v_exp_f32_e64 v11, v11 clamp
    v_exp_f32_e64 v12, v12 clamp
    v_exp_f32_e64 v13, v13 clamp
    v_exp_f32_e64 v14, v14 clamp
    v_exp_f32_e64 v15, v15 clamp
    v_exp_f32_e64 v16, v16 clamp
    v_exp_f32_e64 v17, v17 clamp
    v_exp_f32_e64 v18, v18 clamp
    v_exp_f32_e64 v19, v19 clamp
    v_exp_f32_e64 v20, v20 clamp
    v_exp_f32_e64 v21, v21 clamp
    v_exp_f32_e64 v22, v22 clamp
    v_exp_f32_e64 v23, v23 clamp
    v_max_f32 v64, s60, v64
    v_max_f32 v65, s60, v65
    v_max_f32 v66, s60, v66
    v_max_f32 v67, s60, v67
    v_max_f32 v68, s60, v68
    v_max_f32 v69, s60, v69
    v_max_f32 v70, s60, v70
    v_max_f32 v71, s60, v71
    v_max_f32 v72, s60, v72
    v_max_f32 v73, s60, v73
    v_max_f32 v74, s60, v74
    v_max_f32 v75, s60, v75
    v_max_f32 v76, s60, v76
    v_max_f32 v77, s60, v77
    v_max_f32 v78, s60, v78
    v_max_f32 v79, s60, v79
    v_pk_add_f32 v[64:65], v[64:65], v[8:9]
    v_pk_add_f32 v[66:67], v[66:67], v[10:11]
    v_pk_add_f32 v[68:69], v[68:69], v[12:13]
    v_pk_add_f32 v[70:71], v[70:71], v[14:15]
    v_pk_add_f32 v[72:73], v[72:73], v[16:17]
    v_pk_add_f32 v[74:75], v[74:75], v[18:19]
    v_pk_add_f32 v[76:77], v[76:77], v[20:21]
    v_pk_add_f32 v[78:79], v[78:79], v[22:23]
    v_cvt_pk_bf16_f32 v24, v64, v65
    v_cvt_pk_bf16_f32 v25, v66, v67
    v_cvt_pk_bf16_f32 v26, v68, v69
    v_cvt_pk_bf16_f32 v27, v70, v71
    v_cvt_pk_bf16_f32 v28, v72, v73
    v_cvt_pk_bf16_f32 v29, v74, v75
    v_cvt_pk_bf16_f32 v30, v76, v77
    v_cvt_pk_bf16_f32 v31, v78, v79
    v_cvt_pk_bf16_f32 v32, v80, v81
    v_cvt_pk_bf16_f32 v33, v82, v83
    v_cvt_pk_bf16_f32 v34, v84, v85
    v_cvt_pk_bf16_f32 v35, v86, v87
    v_cvt_pk_bf16_f32 v36, v88, v89
    v_cvt_pk_bf16_f32 v37, v90, v91
    v_cvt_pk_bf16_f32 v38, v92, v93
    v_cvt_pk_bf16_f32 v39, v94, v95
    v_mov_b32 v40, 0x3f803f80
    v_mov_b32 v41, 0x3f803f80
    v_mov_b32 v42, 0x3f803f80
    v_mov_b32 v43, 0x3f803f80
    s_nop 0
    v_mfma_f32_32x32x16_bf16 v[64:79], v[24:27], v[32:35], 0
    v_mfma_f32_32x32x16_bf16 v[80:95], v[24:27], v[40:43], 0
    v_mfma_f32_32x32x16_bf16 v[64:79], v[28:31], v[36:39], v[64:79]
    v_mfma_f32_32x32x16_bf16 v[80:95], v[28:31], v[40:43], v[80:95]
    s_nop 7
    s_nop 3
    s_mov_b32 exec_lo, 0xffff0000
    s_mov_b32 exec_hi, 0xffff0000
    v_mov_b32 v64, v80
    v_mov_b32 v65, v81
    v_mov_b32 v66, v82
    v_mov_b32 v67, v83
    v_mov_b32 v68, v84
    v_mov_b32 v69, v85
    v_mov_b32 v70, v86
    v_mov_b32 v71, v87
    s_mov_b32 exec_lo, 0x0000ffff
    s_mov_b32 exec_hi, 0x0000ffff
    v_mov_b32 v72, v88
    v_mov_b32 v73, v89
    v_mov_b32 v74, v90
    v_mov_b32 v75, v91
    v_mov_b32 v76, v92
    v_mov_b32 v77, v93
    v_mov_b32 v78, v94
    v_mov_b32 v79, v95
    s_mov_b64 exec, -1
    v_lshlrev_b32 v2, 4, v1
    s_lshl_b32 s48, s3, 12
    s_add_u32 s48, s48, 98304
    v_add_u32 v3, s48, v2
    ds_write_b128 v3, v[64:67] offset:0
    ds_write_b128 v3, v[68:71] offset:1024
    ds_write_b128 v3, v[72:75] offset:2048
    ds_write_b128 v3, v[76:79] offset:3072
    s_waitcnt lgkmcnt(0)
    s_mov_b64 exec, 1
    v_mov_b32 v125, 1
    ds_add_rtn_u32 v125, v124, v125 offset:0
    s_mov_b64 exec, -1
    s_waitcnt lgkmcnt(0)
    v_readfirstlane_b32 s53, v125
    s_add_u32 s53, s53, 1
    s_cmp_ge_u32 s53, 36
    s_cbranch_scc1 Lswd_71
    s_mov_b32 s56, 0
Llw_72:
    ds_read_b32 v125, v124 offset:0
    s_add_u32 s56, s56, 1
    s_waitcnt lgkmcnt(0)
    v_readfirstlane_b32 s53, v125
    s_cmp_ge_u32 s53, 36
    s_cbranch_scc1 Llwd_73
    s_sleep 1
    s_cmp_lt_u32 s56, 4000000
    s_cbranch_scc1 Llw_72
Llwd_73:
Lswd_71:
    s_cmp_ge_u32 s3, 2
    s_cbranch_scc1 LB_nored
    s_lshl_b32 s48, s3, 11
    s_add_u32 s48, s48, 98304
    v_add_u32 v3, s48, v2
    ds_read_b128 v[64:67], v3 offset:0
    ds_read_b128 v[68:71], v3 offset:1024
    ds_read_b128 v[72:75], v3 offset:4096
    ds_read_b128 v[76:79], v3 offset:5120
    ds_read_b128 v[80:83], v3 offset:8192
    ds_read_b128 v[84:87], v3 offset:9216
    ds_read_b128 v[88:91], v3 offset:12288
    ds_read_b128 v[92:95], v3 offset:13312
    s_waitcnt lgkmcnt(0)
    v_add_f32 v64, v64, v72
    v_add_f32 v80, v80, v88
    v_add_f32 v65, v65, v73
    v_add_f32 v81, v81, v89
    v_add_f32 v66, v66, v74
    v_add_f32 v82, v82, v90
    v_add_f32 v67, v67, v75
    v_add_f32 v83, v83, v91
    v_add_f32 v68, v68, v76
    v_add_f32 v84, v84, v92
    v_add_f32 v69, v69, v77
    v_add_f32 v85, v85, v93
    v_add_f32 v70, v70, v78
    v_add_f32 v86, v86, v94
    v_add_f32 v71, v71, v79
    v_add_f32 v87, v87, v95
    v_add_f32 v64, v64, v80
    v_add_f32 v65, v65, v81
    v_add_f32 v66, v66, v82
    v_add_f32 v67, v67, v83
    v_add_f32 v68, v68, v84
    v_add_f32 v69, v69, v85
    v_add_f32 v70, v70, v86
    v_add_f32 v71, v71, v87
    s_waitcnt vmcnt(0)
    v_cmp_ne_u32 vcc, s36, v46
    s_cbranch_vccz LB_zok
    s_mov_b32 s56, 0
Lgp_74:
    buffer_load_dword v46, v45, s[32:35], s59 offen sc1
    s_add_u32 s56, s56, 1
    s_waitcnt vmcnt(0)
    v_cmp_ne_u32 vcc, s36, v46
    s_cbranch_vccz Lgpd_75
    s_sleep 2
    s_cmp_lt_u32 s56, 400000
    s_cbranch_scc1 Lgp_74
Lgpd_75:
LB_zok:
    v_lshlrev_b32 v3, 2, v1
    s_lshl_b32 s49, s43, 12
    s_lshl_b32 s50, s3, 11
    s_add_u32 s49, s49, s50
    s_add_u32 s49, s49, 262144
    buffer_atomic_add_f32 v64, v3, s[32:35], s49 offen offset:0
    buffer_atomic_add_f32 v65, v3, s[32:35], s49 offen offset:256
    buffer_atomic_add_f32 v66, v3, s[32:35], s49 offen offset:512
    buffer_atomic_add_f32 v67, v3, s[32:35], s49 offen offset:768
    buffer_atomic_add_f32 v68, v3, s[32:35], s49 offen offset:1024
    buffer_atomic_add_f32 v69, v3, s[32:35], s49 offen offset:1280
    buffer_atomic_add_f32 v70, v3, s[32:35], s49 offen offset:1536
    buffer_atomic_add_f32 v71, v3, s[32:35], s49 offen offset:1792
    s_lshl_b32 s48, s43, 4
    s_add_u32 s48, s48, s42
    s_lshl_b32 s48, s48, 7
    s_lshl_b32 s50, s3, 15
    s_add_u32 s48, s48, s50
    s_add_u32 s48, s48, 12189696
    s_mov_b32 s59, s48
    s_mul_i32 s51, s3, 8192
    s_add_u32 m0, s51, 126976
    s_lshl_b32 s48, s51, 2
    s_lshl_b32 s51, s47, 8
    s_add_u32 s48, s48, s51
    s_add_u32 s48, s48, 131072
    s_add_u32 s52, s48, 32768
Lwr_76:
    buffer_load_dwordx4 v104, s[24:27], s48 offen lds
    s_add_u32 m0, m0, 1024
    s_add_u32 s48, s48, 4096
    s_cmp_lt_u32 s48, s52
    s_cbranch_scc1 Lwr_76
    s_waitcnt vmcnt(8)
    s_mov_b64 exec, 1
    v_mov_b32 v8, 0
    v_mov_b32 v9, s36
    buffer_store_dword v9, v8, s[32:35], s59 offen sc1
    s_mov_b64 exec, -1
    s_branch LB_red
LB_nored:
    s_mul_i32 s51, s3, 8192
    s_add_u32 m0, s51, 126976
    s_lshl_b32 s48, s51, 2
    s_lshl_b32 s51, s47, 8
    s_add_u32 s48, s48, s51
    s_add_u32 s48, s48, 131072
    s_add_u32 s52, s48, 32768
Lwr_77:
    buffer_load_dwordx4 v104, s[24:27], s48 offen lds
    s_add_u32 m0, m0, 1024
    s_add_u32 s48, s48, 4096
    s_cmp_lt_u32 s48, s52
    s_cbranch_scc1 Lwr_77
LB_red:
    v_add_u32 v106, 61440, v105
    s_waitcnt vmcnt(0)
    s_mov_b64 exec, 1
    v_mov_b32 v125, 1
    ds_add_rtn_u32 v125, v124, v125 offset:0
    s_mov_b64 exec, -1
    s_waitcnt lgkmcnt(0)
    v_readfirstlane_b32 s53, v125
    s_add_u32 s53, s53, 1
    s_cmp_ge_u32 s53, 40
    s_cbranch_scc1 Lswd_78
    s_mov_b32 s56, 0
Llw_79:
    ds_read_b32 v125, v124 offset:0
    s_add_u32 s56, s56, 1
    s_waitcnt lgkmcnt(0)
    v_readfirstlane_b32 s53, v125
    s_cmp_ge_u32 s53, 40
    s_cbranch_scc1 Llwd_80
    s_sleep 1
    s_cmp_lt_u32 s56, 4000000
    s_cbranch_scc1 Llw_79
Llwd_80:
Lswd_78:
    s_mul_i32 s51, s3, 7168
    s_add_u32 m0, s51, 98304
    s_lshl_b32 s48, s51, 2
    s_lshl_b32 s51, s47, 8
    s_add_u32 s48, s48, s51
    s_add_u32 s48, s48, 393216
    s_add_u32 s52, s48, 28672
Lwr_81:
    buffer_load_dwordx4 v104, s[24:27], s48 offen lds
    s_add_u32 m0, m0, 1024
    s_add_u32 s48, s48, 4096
    s_cmp_lt_u32 s48, s52
    s_cbranch_scc1 Lwr_81
    ds_read_b64_tr_b16 v[128:129], v105 offset:0
    ds_read_b64_tr_b16 v[130:131], v105 offset:2048
    ds_read_b64_tr_b16 v[132:133], v105 offset:4096
    ds_read_b64_tr_b16 v[134:135], v105 offset:6144
    ds_read_b64_tr_b16 v[136:137], v105 offset:8192
    ds_read_b64_tr_b16 v[138:139], v105 offset:10240
    ds_read_b64_tr_b16 v[140:141], v105 offset:12288
    ds_read_b64_tr_b16 v[142:143], v105 offset:14336
    ds_read_b64_tr_b16 v[144:145], v105 offset:16384
    ds_read_b64_tr_b16 v[146:147], v105 offset:18432
    ds_read_b64_tr_b16 v[148:149], v105 offset:20480
    ds_read_b64_tr_b16 v[150:151], v105 offset:22528
    ds_read_b64_tr_b16 v[152:153], v105 offset:24576
    ds_read_b64_tr_b16 v[154:155], v105 offset:26624
    ds_read_b64_tr_b16 v[156:157], v105 offset:28672
    ds_read_b64_tr_b16 v[158:159], v105 offset:30720
    ds_read_b64_tr_b16 v[160:161], v106 offset:0
    ds_read_b64_tr_b16 v[162:163], v106 offset:2048
    ds_read_b64_tr_b16 v[164:165], v106 offset:4096
    ds_read_b64_tr_b16 v[166:167], v106 offset:6144
    ds_read_b64_tr_b16 v[168:169], v106 offset:8192
    ds_read_b64_tr_b16 v[170:171], v106 offset:10240
    ds_read_b64_tr_b16 v[172:173], v106 offset:12288
    ds_read_b64_tr_b16 v[174:175], v106 offset:14336
    ds_read_b64_tr_b16 v[176:177], v106 offset:16384
    ds_read_b64_tr_b16 v[178:179], v106 offset:18432
    ds_read_b64_tr_b16 v[180:181], v106 offset:20480
    ds_read_b64_tr_b16 v[182:183], v106 offset:22528
    ds_read_b64_tr_b16 v[184:185], v106 offset:24576
    ds_read_b64_tr_b16 v[186:187], v106 offset:26624
    ds_read_b64_tr_b16 v[188:189], v106 offset:28672
    ds_read_b64_tr_b16 v[190:191], v106 offset:30720
    s_waitcnt lgkmcnt(0)
    s_mov_b64 exec, 1
    v_mov_b32 v125, 1
    ds_add_rtn_u32 v125, v124, v125 offset:0
    s_mov_b64 exec, -1
    s_waitcnt lgkmcnt(0)
    v_readfirstlane_b32 s53, v125
    s_add_u32 s53, s53, 1
    s_cmp_ge_u32 s53, 44
    s_cbranch_scc1 Lswd_82
    s_mov_b32 s56, 0
Llw_83:
    ds_read_b32 v125, v124 offset:0
    s_add_u32 s56, s56, 1
    s_waitcnt lgkmcnt(0)
    v_readfirstlane_b32 s53, v125
    s_cmp_ge_u32 s53, 44
    s_cbranch_scc1 Llwd_84
    s_sleep 1
    s_cmp_lt_u32 s56, 4000000
    s_cbranch_scc1 Llw_83
Llwd_84:
Lswd_82:
    s_mul_i32 s51, s3, 8192
    s_add_u32 m0, s51, 65536
    s_lshl_b32 s48, s51, 2
    s_lshl_b32 s51, s47, 8
    s_add_u32 s48, s48, s51
    s_add_u32 s48, s48, 262144
    s_add_u32 s52, s48, 32768
Lwr_85:
    buffer_load_dwordx4 v104, s[24:27], s48 offen lds
    s_add_u32 m0, m0, 1024
    s_add_u32 s48, s48, 4096
    s_cmp_lt_u32 s48, s52
    s_cbranch_scc1 Lwr_85
    s_mul_i32 s51, s3, 1024
    s_add_u32 m0, s51, 126976
    s_lshl_b32 s48, s51, 2
    s_lshl_b32 s51, s47, 8
    s_add_u32 s48, s48, s51
    s_add_u32 s48, s48, 507904
    s_add_u32 s52, s48, 4096
Lwr_86:
    buffer_load_dwordx4 v104, s[24:27], s48 offen lds
    s_add_u32 m0, m0, 1024
    s_add_u32 s48, s48, 4096
    s_cmp_lt_u32 s48, s52
    s_cbranch_scc1 Lwr_86
    s_waitcnt vmcnt(0)
    s_mov_b64 exec, 1
    v_mov_b32 v125, 1
    ds_add_rtn_u32 v125, v124, v125 offset:0
    s_mov_b64 exec, -1
    s_waitcnt lgkmcnt(0)
    v_readfirstlane_b32 s53, v125
    s_add_u32 s53, s53, 1
    s_cmp_ge_u32 s53, 48
    s_cbranch_scc1 Lswd_87
    s_mov_b32 s56, 0
Llw_88:
    ds_read_b32 v125, v124 offset:0
    s_add_u32 s56, s56, 1
    s_waitcnt lgkmcnt(0)
    v_readfirstlane_b32 s53, v125
    s_cmp_ge_u32 s53, 48
    s_cbranch_scc1 Llwd_89
    s_sleep 1
    s_cmp_lt_u32 s56, 4000000
    s_cbranch_scc1 Llw_88
Llwd_89:
Lswd_87:
    ds_read_b64_tr_b16 v[192:193], v105 offset:0
    ds_read_b64_tr_b16 v[194:195], v105 offset:2048
    ds_read_b64_tr_b16 v[196:197], v105 offset:4096
    ds_read_b64_tr_b16 v[198:199], v105 offset:6144
    ds_read_b64_tr_b16 v[200:201], v105 offset:8192
    ds_read_b64_tr_b16 v[202:203], v105 offset:10240
    ds_read_b64_tr_b16 v[204:205], v105 offset:12288
    ds_read_b64_tr_b16 v[206:207], v105 offset:14336
    ds_read_b64_tr_b16 v[208:209], v105 offset:16384
    ds_read_b64_tr_b16 v[210:211], v105 offset:18432
    ds_read_b64_tr_b16 v[212:213], v105 offset:20480
    ds_read_b64_tr_b16 v[214:215], v105 offset:22528
    ds_read_b64_tr_b16 v[216:217], v105 offset:24576
    ds_read_b64_tr_b16 v[218:219], v105 offset:26624
    ds_read_b64_tr_b16 v[220:221], v105 offset:28672
    ds_read_b64_tr_b16 v[222:223], v105 offset:30720
    ds_read_b64_tr_b16 v[224:225], v105 offset:32768
    ds_read_b64_tr_b16 v[226:227], v105 offset:34816
    ds_read_b64_tr_b16 v[228:229], v105 offset:36864
    ds_read_b64_tr_b16 v[230:231], v105 offset:38912
    ds_read_b64_tr_b16 v[232:233], v105 offset:40960
    ds_read_b64_tr_b16 v[234:235], v105 offset:43008
    ds_read_b64_tr_b16 v[236:237], v105 offset:45056
    ds_read_b64_tr_b16 v[238:239], v105 offset:47104
    ds_read_b64_tr_b16 v[240:241], v105 offset:49152
    ds_read_b64_tr_b16 v[242:243], v105 offset:51200
    ds_read_b64_tr_b16 v[244:245], v105 offset:53248
    ds_read_b64_tr_b16 v[246:247], v105 offset:55296
    ds_read_b64_tr_b16 v[248:249], v105 offset:57344
    ds_read_b64_tr_b16 v[250:251], v105 offset:59392
    ds_read_b64_tr_b16 v[252:253], v106 offset:0
    ds_read_b64_tr_b16 v[254:255], v106 offset:2048
    s_waitcnt lgkmcnt(0)
    s_mov_b64 exec, 1
    ds_add_u32 v124, v111
    s_mov_b64 exec, -1
    s_mov_b32 s56, 0
Llw_90:
    ds_read_b32 v125, v124 offset:0
    s_add_u32 s56, s56, 1
    s_waitcnt lgkmcnt(0)
    v_readfirstlane_b32 s53, v125
    s_cmp_ge_u32 s53, 52
    s_cbranch_scc1 Llwd_91
    s_sleep 1
    s_cmp_lt_u32 s56, 4000000
    s_cbranch_scc1 Llw_90
Llwd_91:
    s_mul_i32 s51, s3, 15360
    s_add_u32 m0, s51, 65536
    s_lshl_b32 s48, s51, 2
    s_lshl_b32 s51, s47, 8
    s_add_u32 s48, s48, s51
    s_add_u32 s52, s48, 61440
Lwr_92:
    buffer_load_dwordx4 v104, s[12:15], s48 offen lds
    s_add_u32 m0, m0, 1024
    s_add_u32 s48, s48, 4096
    s_cmp_lt_u32 s48, s52
    s_cbranch_scc1 Lwr_92
    s_cmp_lg_u32 s3, 3
    s_cbranch_scc1 LB_np2
    v_and_b32 v6, 15, v1
    v_lshlrev_b32 v6, 7, v6
    v_bfe_u32 v7, v1, 4, 1
    v_lshl_add_u32 v6, v7, 15, v6
    s_lshl_b32 s48, s43, 11
    s_add_u32 s48, s48, 12189696
    s_mov_b32 exec_hi, 0
    s_mov_b32 s56, 0
Lgp_93:
    buffer_load_dword v7, v6, s[32:35], s48 offen sc1
    s_add_u32 s56, s56, 1
    s_waitcnt vmcnt(0)
    v_cmp_ne_u32 vcc, s36, v7
    s_cbranch_vccz Lgpd_94
    s_sleep 4
    s_cmp_lt_u32 s56, 400000
    s_cbranch_scc1 Lgp_93
Lgpd_94:
    s_mov_b64 exec, 1
    v_mov_b32 v125, 1
    ds_add_u32 v124, v125 offset:8
    s_mov_b64 exec, -1
LB_np2:
    s_mov_b32 s56, 0
Llw_95:
    ds_read_b32 v125, v124 offset:8
    s_add_u32 s56, s56, 1
    s_waitcnt lgkmcnt(0)
    v_readfirstlane_b32 s53, v125
    s_cmp_ge_u32 s53, 1
    s_cbranch_scc1 Llwd_96
    s_sleep 1
    s_cmp_lt_u32 s56, 4000000
    s_cbranch_scc1 Llw_95
Llwd_96:
    v_mov_b32 v110, 64
    s_waitcnt vmcnt(0)
    ds_write_b32 v108, v110
    v_lshlrev_b32 v3, 2, v1
    s_lshl_b32 s49, s43, 12
    s_add_u32 s49, s49, 262144
    buffer_load_dword v80, v3, s[32:35], s49 offen offset:0 sc1
    buffer_load_dword v81, v3, s[32:35], s49 offen offset:256 sc1
    buffer_load_dword v82, v3, s[32:35], s49 offen offset:512 sc1
    buffer_load_dword v83, v3, s[32:35], s49 offen offset:768 sc1
    buffer_load_dword v84, v3, s[32:35], s49 offen offset:1024 sc1
    buffer_load_dword v85, v3, s[32:35], s49 offen offset:1280 sc1
    buffer_load_dword v86, v3, s[32:35], s49 offen offset:1536 sc1
    buffer_load_dword v87, v3, s[32:35], s49 offen offset:1792 sc1
    buffer_load_dword v88, v3, s[32:35], s49 offen offset:2048 sc1
    buffer_load_dword v89, v3, s[32:35], s49 offen offset:2304 sc1
    buffer_load_dword v90, v3, s[32:35], s49 offen offset:2560 sc1
    buffer_load_dword v91, v3, s[32:35], s49 offen offset:2816 sc1
    buffer_load_dword v92, v3, s[32:35], s49 offen offset:3072 sc1
    buffer_load_dword v93, v3, s[32:35], s49 offen offset:3328 sc1
    buffer_load_dword v94, v3, s[32:35], s49 offen offset:3584 sc1
    buffer_load_dword v95, v3, s[32:35], s49 offen offset:3840 sc1
    v_fma_f32 v8, v48, s57, v44
    v_fma_f32 v9, v49, s57, v44
    v_fma_f32 v10, v50, s57, v44
    v_fma_f32 v11, v51, s57, v44
    v_fma_f32 v12, v52, s57, v44
    v_fma_f32 v13, v53, s57, v44
    v_fma_f32 v14, v54, s57, v44
    v_fma_f32 v15, v55, s57, v44
    v_fma_f32 v16, v56, s57, v44
    v_fma_f32 v17, v57, s57, v44
    v_fma_f32 v18, v58, s57, v44
    v_fma_f32 v19, v59, s57, v44
    v_fma_f32 v20, v60, s57, v44
    v_fma_f32 v21, v61, s57, v44
    v_fma_f32 v22, v62, s57, v44
    v_fma_f32 v23, v63, s57, v44
    v_exp_f32_e64 v8, v8 clamp
    v_exp_f32_e64 v9, v9 clamp
    v_exp_f32_e64 v10, v10 clamp
    v_exp_f32_e64 v11, v11 clamp
    v_exp_f32_e64 v12, v12 clamp
    v_exp_f32_e64 v13, v13 clamp
    v_exp_f32_e64 v14, v14 clamp
    v_exp_f32_e64 v15, v15 clamp
    v_exp_f32_e64 v16, v16 clamp
    v_exp_f32_e64 v17, v17 clamp
    v_exp_f32_e64 v18, v18 clamp
    v_exp_f32_e64 v19, v19 clamp
    v_exp_f32_e64 v20, v20 clamp
    v_exp_f32_e64 v21, v21 clamp
    v_exp_f32_e64 v22, v22 clamp
    v_exp_f32_e64 v23, v23 clamp
    v_max_f32 v48, s60, v48
    v_max_f32 v49, s60, v49
    v_max_f32 v50, s60, v50
    v_max_f32 v51, s60, v51
    v_max_f32 v52, s60, v52
    v_max_f32 v53, s60, v53
    v_max_f32 v54, s60, v54
    v_max_f32 v55, s60, v55
    v_max_f32 v56, s60, v56
    v_max_f32 v57, s60, v57
    v_max_f32 v58, s60, v58
    v_max_f32 v59, s60, v59
    v_max_f32 v60, s60, v60
    v_max_f32 v61, s60, v61
    v_max_f32 v62, s60, v62
    v_max_f32 v63, s60, v63
    v_add_f32 v48, v48, v8
    v_add_f32 v49, v49, v9
    v_add_f32 v50, v50, v10
    v_add_f32 v51, v51, v11
    v_add_f32 v52, v52, v12
    v_add_f32 v53, v53, v13
    v_add_f32 v54, v54, v14
    v_add_f32 v55, v55, v15
    v_add_f32 v56, v56, v16
    v_add_f32 v57, v57, v17
    v_add_f32 v58, v58, v18
    v_add_f32 v59, v59, v19
    v_add_f32 v60, v60, v20
    v_add_f32 v61, v61, v21
    v_add_f32 v62, v62, v22
    v_add_f32 v63, v63, v23
    v_cvt_pk_bf16_f32 v112, v48, v49
    v_cvt_pk_bf16_f32 v113, v50, v51
    v_cvt_pk_bf16_f32 v114, v52, v53
    v_cvt_pk_bf16_f32 v115, v54, v55
    v_cvt_pk_bf16_f32 v116, v56, v57
    v_cvt_pk_bf16_f32 v117, v58, v59
    v_cvt_pk_bf16_f32 v118, v60, v61
    v_cvt_pk_bf16_f32 v119, v62, v63
    s_lshl_b32 s48, s42, 4
    s_add_u32 s48, s48, s43
    s_lshl_b32 s48, s48, 7
    s_lshl_b32 s51, s3, 15
    s_add_u32 s48, s48, s51
    s_add_u32 s59, s48, 12320768
    v_mov_b32 v6, 0
    v_mov_b32 v7, s36
    s_waitcnt vmcnt(0)
    v_cvt_pk_bf16_f32 v24, v80, v81
    v_cvt_pk_bf16_f32 v25, v82, v83
    v_cvt_pk_bf16_f32 v26, v84, v85
    v_cvt_pk_bf16_f32 v27, v86, v87
    v_cvt_pk_bf16_f32 v28, v88, v89
    v_cvt_pk_bf16_f32 v29, v90, v91
    v_cvt_pk_bf16_f32 v30, v92, v93
    v_cvt_pk_bf16_f32 v31, v94, v95
    s_mov_b64 exec, 1
    buffer_store_dword v7, v6, s[32:35], s59 offen sc1
    s_mov_b64 exec, -1
    v_mfma_f32_32x32x16_bf16 v[48:63], v[24:27], v[112:115], 0
    v_mfma_f32_32x32x16_bf16 v[64:79], v[28:31], v[116:119], 0
    s_nop 7
    s_nop 5
    s_nop 3
    v_add_f32 v8, s60, v56
    v_add_f32 v9, s60, v64
    v_rcp_f32 v8, v8
    v_rcp_f32 v9, v9
    s_nop 0
    v_mul_f32 v48, v48, v8
    v_mul_f32 v49, v49, v8
    v_mul_f32 v50, v50, v8
    v_mul_f32 v51, v51, v8
    v_mul_f32 v52, v52, v8
    v_mul_f32 v53, v53, v8
    v_mul_f32 v54, v54, v8
    v_mul_f32 v55, v55, v8
    v_mul_f32 v72, v72, v9
    v_mul_f32 v73, v73, v9
    v_mul_f32 v74, v74, v9
    v_mul_f32 v75, v75, v9
    v_mul_f32 v76, v76, v9
    v_mul_f32 v77, v77, v9
    v_mul_f32 v78, v78, v9
    v_mul_f32 v79, v79, v9
    v_cvt_pk_bf16_f32 v16, v48, v49
    v_cvt_pk_bf16_f32 v17, v50, v51
    v_cvt_pk_bf16_f32 v18, v52, v53
    v_cvt_pk_bf16_f32 v19, v54, v55
    v_cvt_pk_bf16_f32 v20, v72, v73
    v_cvt_pk_bf16_f32 v21, v74, v75
    v_cvt_pk_bf16_f32 v22, v76, v77
    v_cvt_pk_bf16_f32 v23, v78, v79
    v_min_u32 v16, -2, v16
    v_min_u32 v19, -2, v19
    v_min_u32 v20, -2, v20
    v_min_u32 v23, -2, v23
    buffer_store_dwordx4 v[16:19], v107, s[32:35], s63 offen sc1
    buffer_store_dwordx4 v[20:23], v107, s[32:35], s63 offen offset:1024 sc1
    s_mov_b32 s56, 0
Lpw_97:
    ds_read_b32 v125, v109
    s_add_u32 s56, s56, 1
    s_waitcnt lgkmcnt(0)
    v_cmp_gt_u32 vcc, 8, v125
    s_cbranch_vccz Lpwd_98
    s_sleep 2
    s_cmp_lt_u32 s56, 4000000
    s_cbranch_scc1 Lpw_97
Lpwd_98:
    s_mul_i32 s51, s3, 8192
    s_add_u32 m0, s51, 0
    s_lshl_b32 s48, s51, 2
    s_lshl_b32 s51, s47, 8
    s_add_u32 s48, s48, s51
    s_add_u32 s48, s48, 245760
    s_add_u32 s52, s48, 32768
Lwr_99:
    buffer_load_dwordx4 v104, s[12:15], s48 offen lds
    s_add_u32 m0, m0, 1024
    s_add_u32 s48, s48, 4096
    s_cmp_lt_u32 s48, s52
    s_cbranch_scc1 Lwr_99
    s_setprio 0
    s_setprio 2
    s_mov_b32 s56, 0
Llw_100:
    ds_read_b32 v125, v124 offset:44
    s_add_u32 s56, s56, 1
    s_waitcnt lgkmcnt(0)
    v_readfirstlane_b32 s53, v125
    s_cmp_ge_u32 s53, 4
    s_cbranch_scc1 Llwd_101
    s_sleep 1
    s_cmp_lt_u32 s56, 4000000
    s_cbranch_scc1 Llw_100
Llwd_101:
    s_mul_i32 s51, s3, 9216
    s_add_u32 m0, s51, 65536
    s_lshl_b32 s48, s51, 2
    s_lshl_b32 s51, s47, 8
    s_add_u32 s48, s48, s51
    s_add_u32 s48, s48, 376832
    s_add_u32 s52, s48, 36864
Lwr_102:
    buffer_load_dwordx4 v104, s[12:15], s48 offen lds
    s_add_u32 m0, m0, 1024
    s_add_u32 s48, s48, 4096
    s_cmp_lt_u32 s48, s52
    s_cbranch_scc1 Lwr_102
    v_mov_b32 v110, 128
    s_waitcnt vmcnt(0)
    ds_write_b32 v108, v110
    v_lshlrev_b32 v6, 7, v1
    s_lshr_b32 s48, s46, 2
    s_lshl_b32 s48, s48, 11
    s_and_b32 s51, s46, 3
    s_lshl_b32 s51, s51, 15
    s_add_u32 s48, s48, s51
    s_lshl_b32 s51, s3, 9
    s_add_u32 s48, s48, s51
    s_add_u32 s59, s48, 12320768
    s_mov_b64 exec, 0xf
    s_mov_b32 s56, 0
Lgp_103:
    buffer_load_dword v7, v6, s[32:35], s59 offen sc1
    s_add_u32 s56, s56, 1
    s_waitcnt vmcnt(0)
    v_cmp_ne_u32 vcc, s36, v7
    s_cbranch_vccz Lgpd_104
    s_sleep 1
    s_cmp_lt_u32 s56, 400000
    s_cbranch_scc1 Lgp_103
Lgpd_104:
    s_mov_b64 exec, -1
    s_mov_b32 s54, 56
LB_try:
    s_lshl_b32 s52, s3, 13
    s_add_u32 m0, s52, 126976
    s_lshl_b32 s51, s46, 15
    s_add_u32 s51, s51, 7340032
    v_add_u32 v5, 126976, v107
    v_lshlrev_b32 v7, 7, v1
    s_mov_b32 s49, m0
    v_add_u32 v7, s49, v7
    s_mov_b32 s50, 0
Lq_105:
    s_mov_b32 m0, s49
    s_add_u32 s48, s51, s52
    buffer_load_dwordx4 v107, s[32:35], s48 offen offset:0 sc1 lds
    buffer_load_dwordx4 v107, s[32:35], s48 offen offset:1024 sc1 lds
    buffer_load_dwordx4 v107, s[32:35], s48 offen offset:2048 sc1 lds
    buffer_load_dwordx4 v107, s[32:35], s48 offen offset:3072 sc1 lds
    s_add_u32 m0, m0, 4096
    s_add_u32 s48, s48, 4096
    buffer_load_dwordx4 v107, s[32:35], s48 offen offset:0 sc1 lds
    buffer_load_dwordx4 v107, s[32:35], s48 offen offset:1024 sc1 lds
    buffer_load_dwordx4 v107, s[32:35], s48 offen offset:2048 sc1 lds
    buffer_load_dwordx4 v107, s[32:35], s48 offen offset:3072 sc1 lds
    s_waitcnt vmcnt(0)
    ds_read_b32 v125, v7
    s_add_u32 s50, s50, 1
    s_waitcnt lgkmcnt(0)
    v_cmp_eq_u32 vcc, -1, v125
    s_cbranch_vccz Lqd_106
    s_cmp_lt_u32 s50, 400000
    s_cbranch_scc1 Lq_105
Lqd_106:
    s_mov_b64 exec, 1
    v_mov_b32 v125, 1
    ds_add_rtn_u32 v125, v124, v125 offset:0
    s_mov_b64 exec, -1
    s_waitcnt lgkmcnt(0)
    v_readfirstlane_b32 s53, v125
    s_add_u32 s53, s53, 1
    s_cmp_ge_u32 s53, s54
    s_cbranch_scc1 Lswd_107
    s_mov_b32 s56, 0
Llw_108:
    ds_read_b32 v125, v124 offset:0
    s_add_u32 s56, s56, 1
    s_waitcnt lgkmcnt(0)
    v_readfirstlane_b32 s53, v125
    s_cmp_ge_u32 s53, s54
    s_cbranch_scc1 Llwd_109
    s_cmp_lt_u32 s56, 4000000
    s_cbranch_scc1 Llw_108
Llwd_109:
Lswd_107:
    s_mov_b32 s56, 0
Llw_110:
    ds_read_b32 v125, v124 offset:40
    s_add_u32 s56, s56, 1
    s_waitcnt lgkmcnt(0)
    v_readfirstlane_b32 s53, v125
    s_cmp_ge_u32 s53, 4
    s_cbranch_scc1 Llwd_111
    s_sleep 1
    s_cmp_lt_u32 s56, 4000000
    s_cbranch_scc1 Llw_110
Llwd_111:
    s_setprio 2
    ds_read_b128 v[8:11], v5 offset:0
    ds_read_b128 v[12:15], v5 offset:1024
    ds_read_b128 v[16:19], v5 offset:2048
    ds_read_b128 v[20:23], v5 offset:3072
    ds_read_b128 v[24:27], v5 offset:4096
    ds_read_b128 v[28:31], v5 offset:5120
    ds_read_b128 v[32:35], v5 offset:6144
    ds_read_b128 v[36:39], v5 offset:7168
    s_waitcnt lgkmcnt(7)
    v_mfma_f32_32x32x16_bf16 v[48:63], v[128:131], v[8:11], 0
    v_max3_u32 v41, v8, v11, v8
    ds_read_b128 v[8:11], v5 offset:8192
    s_waitcnt lgkmcnt(7)
    v_mfma_f32_32x32x16_bf16 v[48:63], v[132:135], v[12:15], v[48:63]
    v_max3_u32 v41, v12, v15, v41
    ds_read_b128 v[12:15], v5 offset:9216
    s_waitcnt lgkmcnt(7)
    v_mfma_f32_32x32x16_bf16 v[48:63], v[136:139], v[16:19], v[48:63]
    v_max3_u32 v41, v16, v19, v41
    ds_read_b128 v[16:19], v5 offset:10240
    s_waitcnt lgkmcnt(7)
    v_mfma_f32_32x32x16_bf16 v[48:63], v[140:143], v[20:23], v[48:63]
    v_max3_u32 v41, v20, v23, v41
    ds_read_b128 v[20:23], v5 offset:11264
    s_waitcnt lgkmcnt(7)
    v_mfma_f32_32x32x16_bf16 v[48:63], v[144:147], v[24:27], v[48:63]
    v_max3_u32 v41, v24, v27, v41
    ds_read_b128 v[24:27], v5 offset:12288
    s_waitcnt lgkmcnt(7)
    v_mfma_f32_32x32x16_bf16 v[48:63], v[148:151], v[28:31], v[48:63]
    v_max3_u32 v41, v28, v31, v41
    ds_read_b128 v[28:31], v5 offset:13312
    s_waitcnt lgkmcnt(7)
    v_mfma_f32_32x32x16_bf16 v[48:63], v[152:155], v[32:35], v[48:63]
    v_max3_u32 v41, v32, v35, v41
    ds_read_b128 v[32:35], v5 offset:14336
    s_waitcnt lgkmcnt(7)
    v_mfma_f32_32x32x16_bf16 v[48:63], v[156:159], v[36:39], v[48:63]
    v_max3_u32 v41, v36, v39, v41
    ds_read_b128 v[36:39], v5 offset:15360
    s_waitcnt lgkmcnt(7)
    v_mfma_f32_32x32x16_bf16 v[48:63], v[160:163], v[8:11], v[48:63]
    v_max3_u32 v41, v8, v11, v41
    ds_read_b128 v[8:11], v5 offset:16384
    s_waitcnt lgkmcnt(7)
    v_mfma_f32_32x32x16_bf16 v[48:63], v[164:167], v[12:15], v[48:63]
    v_max3_u32 v41, v12, v15, v41
    ds_read_b128 v[12:15], v5 offset:17408
    s_waitcnt lgkmcnt(7)
    v_mfma_f32_32x32x16_bf16 v[48:63], v[168:171], v[16:19], v[48:63]
    v_max3_u32 v41, v16, v19, v41
    ds_read_b128 v[16:19], v5 offset:18432
    s_waitcnt lgkmcnt(7)
    v_mfma_f32_32x32x16_bf16 v[48:63], v[172:175], v[20:23], v[48:63]
    v_max3_u32 v41, v20, v23, v41
    ds_read_b128 v[20:23], v5 offset:19456
    s_waitcnt lgkmcnt(7)
    v_mfma_f32_32x32x16_bf16 v[48:63], v[176:179], v[24:27], v[48:63]
    v_max3_u32 v41, v24, v27, v41
    ds_read_b128 v[24:27], v5 offset:20480
    s_waitcnt lgkmcnt(7)
    v_mfma_f32_32x32x16_bf16 v[48:63], v[180:183], v[28:31], v[48:63]
    v_max3_u32 v41, v28, v31, v41
    ds_read_b128 v[28:31], v5 offset:21504
    s_waitcnt lgkmcnt(7)
    v_mfma_f32_32x32x16_bf16 v[48:63], v[184:187], v[32:35], v[48:63]
    v_max3_u32 v41, v32, v35, v41
    ds_read_b128 v[32:35], v5 offset:22528
    s_waitcnt lgkmcnt(7)
    v_mfma_f32_32x32x16_bf16 v[48:63], v[188:191], v[36:39], v[48:63]
    v_max3_u32 v41, v36, v39, v41
    ds_read_b128 v[36:39], v5 offset:23552
    s_waitcnt lgkmcnt(7)
    v_mfma_f32_32x32x16_bf16 v[48:63], v[192:195], v[8:11], v[48:63]
    v_max3_u32 v41, v8, v11, v41
    ds_read_b128 v[8:11], v5 offset:24576
    s_waitcnt lgkmcnt(7)
    v_mfma_f32_32x32x16_bf16 v[48:63], v[196:199], v[12:15], v[48:63]
    v_max3_u32 v41, v12, v15, v41
    ds_read_b128 v[12:15], v5 offset:25600
    s_waitcnt lgkmcnt(7)
    v_mfma_f32_32x32x16_bf16 v[48:63], v[200:203], v[16:19], v[48:63]
    v_max3_u32 v41, v16, v19, v41
    ds_read_b128 v[16:19], v5 offset:26624
    s_waitcnt lgkmcnt(7)
    v_mfma_f32_32x32x16_bf16 v[48:63], v[204:207], v[20:23], v[48:63]
    v_max3_u32 v41, v20, v23, v41
    ds_read_b128 v[20:23], v5 offset:27648
    s_waitcnt lgkmcnt(7)
    v_mfma_f32_32x32x16_bf16 v[48:63], v[208:211], v[24:27], v[48:63]
    v_max3_u32 v41, v24, v27, v41
    ds_read_b128 v[24:27], v5 offset:28672
    s_waitcnt lgkmcnt(7)
    v_mfma_f32_32x32x16_bf16 v[48:63], v[212:215], v[28:31], v[48:63]
    v_max3_u32 v41, v28, v31, v41
    ds_read_b128 v[28:31], v5 offset:29696
    s_waitcnt lgkmcnt(7)
    v_mfma_f32_32x32x16_bf16 v[48:63], v[216:219], v[32:35], v[48:63]
    v_max3_u32 v41, v32, v35, v41
    ds_read_b128 v[32:35], v5 offset:30720
    s_waitcnt lgkmcnt(7)
    v_mfma_f32_32x32x16_bf16 v[48:63], v[220:223], v[36:39], v[48:63]
    v_max3_u32 v41, v36, v39, v41
    ds_read_b128 v[36:39], v5 offset:31744
    s_waitcnt lgkmcnt(7)
    v_mfma_f32_32x32x16_bf16 v[48:63], v[224:227], v[8:11], v[48:63]
    v_max3_u32 v41, v8, v11, v41
    s_waitcnt lgkmcnt(6)
    v_mfma_f32_32x32x16_bf16 v[48:63], v[228:231], v[12:15], v[48:63]
    v_max3_u32 v41, v12, v15, v41
    s_waitcnt lgkmcnt(5)
    v_mfma_f32_32x32x16_bf16 v[48:63], v[232:235], v[16:19], v[48:63]
    v_max3_u32 v41, v16, v19, v41
    s_waitcnt lgkmcnt(4)
    v_mfma_f32_32x32x16_bf16 v[48:63], v[236:239], v[20:23], v[48:63]
    v_max3_u32 v41, v20, v23, v41
    s_waitcnt lgkmcnt(3)
    v_mfma_f32_32x32x16_bf16 v[48:63], v[240:243], v[24:27], v[48:63]
    v_max3_u32 v41, v24, v27, v41
    s_waitcnt lgkmcnt(2)
    v_mfma_f32_32x32x16_bf16 v[48:63], v[244:247], v[28:31], v[48:63]
    v_max3_u32 v41, v28, v31, v41
    s_waitcnt lgkmcnt(1)
    v_mfma_f32_32x32x16_bf16 v[48:63], v[248:251], v[32:35], v[48:63]
    v_max3_u32 v41, v32, v35, v41
    s_waitcnt lgkmcnt(0)
    v_mfma_f32_32x32x16_bf16 v[48:63], v[252:255], v[36:39], v[48:63]
    v_max3_u32 v41, v36, v39, v41
    s_setprio 2
    v_cmp_eq_u32 vcc, -1, v41
    s_cbranch_vccz LB_good
    s_add_u32 s54, s54, 4
    s_mov_b64 exec, 1
    v_mov_b32 v125, 1
    ds_add_rtn_u32 v125, v124, v125 offset:0
    s_mov_b64 exec, -1
    s_waitcnt lgkmcnt(0)
    v_readfirstlane_b32 s53, v125
    s_add_u32 s53, s53, 1
    s_cmp_ge_u32 s53, s54
    s_cbranch_scc1 Lswd_112
    s_mov_b32 s56, 0
Llw_113:
    ds_read_b32 v125, v124 offset:0
    s_add_u32 s56, s56, 1
    s_waitcnt lgkmcnt(0)
    v_readfirstlane_b32 s53, v125
    s_cmp_ge_u32 s53, s54
    s_cbranch_scc1 Llwd_114
    s_cmp_lt_u32 s56, 4000000
    s_cbranch_scc1 Llw_113
Llwd_114:
Lswd_112:
    s_add_u32 s54, s54, 4
    s_cmp_lt_u32 s54, 3200000
    s_cbranch_scc1 LB_try
LB_good:
    v_and_b32 v2, 31, v1
    v_lshlrev_b32 v2, 11, v2
    v_lshrrev_b32 v3, 5, v1
    v_lshl_add_u32 v2, v3, 4, v2
    s_lshl_b32 s48, s46, 16
    s_lshl_b32 s49, s47, 8
    s_add_u32 s48, s48, s49
    s_lshl_b32 s49, s3, 6
    s_add_u32 s48, s48, s49
    s_add_u32 s48, s48, 1024
    s_nop 7
    v_cvt_pk_bf16_f32 v8, v48, v49
    v_cvt_pk_bf16_f32 v9, v50, v51
    v_cvt_pk_bf16_f32 v10, v52, v53
    v_cvt_pk_bf16_f32 v11, v54, v55
    v_cvt_pk_bf16_f32 v12, v56, v57
    v_cvt_pk_bf16_f32 v13, v58, v59
    v_cvt_pk_bf16_f32 v14, v60, v61
    v_cvt_pk_bf16_f32 v15, v62, v63
    s_nop 1
    v_permlane32_swap_b32 v8, v10
    v_permlane32_swap_b32 v9, v11
    v_permlane32_swap_b32 v12, v14
    v_permlane32_swap_b32 v13, v15
    buffer_store_dwordx4 v[8:11], v2, s[28:31], s48 offen nt
    buffer_store_dwordx4 v[12:15], v2, s[28:31], s48 offen offset:32 nt
L_end:
    s_endpgm
.section .rodata,"a"
.p2align 6
.amdhsa_kernel concat_heads__softmax_full_mha__linear_attn_block__prompt_kernel
  .amdhsa_next_free_vgpr 256
  .amdhsa_next_free_sgpr 102
  .amdhsa_accum_offset 256
  .amdhsa_group_segment_fixed_size 0
  .amdhsa_kernarg_size 72
  .amdhsa_user_sgpr_count 2
  .amdhsa_user_sgpr_kernarg_segment_ptr 1
  .amdhsa_system_sgpr_workgroup_id_x 1
.end_amdhsa_kernel
```
